```python
import torch

def _softmax(x, axis=-1):
    return torch.softmax(x, dim=axis)
def _gelu(x):
    return torch.nn.functional.gelu(x, approximate="tanh")
def _silu(x):
    return torch.nn.functional.silu(x)
def _sigmoid(x):
    return torch.sigmoid(x)
def _layernorm(x, axis=-1, eps=1e-5):
    m = x.mean(dim=axis, keepdim=True)
    v = x.var(dim=axis, keepdim=True, unbiased=False)
    return (x - m) / torch.sqrt(v + eps)
def _scatter_add(tgt, idx, src, axis=0):
    return tgt.clone().index_add_(axis, idx, src)
def _segment_sum(src, seg, n):
    out = torch.zeros((n,) + src.shape[1:], dtype=src.dtype)
    return out.index_add_(0, seg, src)
def _pad(x, pw):
    flat = tuple(v for pair in reversed(pw) for v in pair)
    return torch.nn.functional.pad(x, flat)

kernel_name = 'standalone__gqa_block_cached__sampling'

def setup_inputs():

    _w = (lambda a: (lambda t: t.to(torch.bfloat16) if t.is_floating_point() else t)(torch.as_tensor(a)))
    B, Sq, D = 8, 16, 448
    Hq, Hkv, Sk, Dh = 16, 8, 2048, 256
    assert Hq % Hkv == 0, (Hq, Hkv)
    return {
        "x": _w((lambda *s: torch.randn(*s, dtype=torch.bfloat16) * 0.8)(B, Sq, D)),
        "k_cache": _w((lambda *s: torch.randn(*s, dtype=torch.bfloat16) * 0.8)(B, Hkv, Sk, Dh)),
        "v_cache": _w((lambda *s: torch.randn(*s, dtype=torch.bfloat16) * 0.05)(B, Hkv, Sk, Dh)),
        "wq": _w((lambda *s: torch.randn(*s, dtype=torch.bfloat16) * 0.8)(D, Hq * Dh) * (D ** -0.5)),
        "wo": _w((lambda *s: torch.randn(*s, dtype=torch.bfloat16) * 0.05)(Hq * Dh, D) * ((Hq * Dh) ** -0.5)),
    }

def reference(x, k_cache, v_cache, wq, wo):
    B, Sq, D = x.shape
    Hq, Dh = 16, 256
    Hkv = k_cache.shape[1]
    rep = Hq // Hkv
    q = (lambda x, *d: x.permute(*d))((x @ wq).reshape(B, Sq, Hq, Dh), 0, 2, 1, 3)
    k = (lambda x, n, axis: torch.repeat_interleave(x, n, dim=axis))(k_cache, rep, axis=1)
    v = (lambda x, n, axis: torch.repeat_interleave(x, n, dim=axis))(v_cache, rep, axis=1)
    scores = torch.einsum("bhqd,bhkd->bhqk", q, k) * (Dh ** -0.5)
    p = _softmax(scores, axis=-1)
    o = torch.einsum("bhqk,bhkd->bhqd", p, v)
    return (lambda x, *d: x.permute(*d))(o, 0, 2, 1, 3).reshape(B, Sq, Hq * Dh) @ wo
```

```asm
; @launch grid=(256,1,1) block=(512,1,1) lds=163840
.amdgcn_target "amdgcn-amd-amdhsa--gfx950"
.text
.globl standalone__gqa_block_cached__sampling_kernel
.p2align 8
.type standalone__gqa_block_cached__sampling_kernel,@function
standalone__gqa_block_cached__sampling_kernel:
    s_cmp_ge_u32 s2, 256
    s_cbranch_scc1 EXIT
    s_load_dwordx16 s[4:19], s[0:1], 0
    v_lshrrev_b32 v1, 6, v0
    v_and_b32 v0, 63, v0
    s_and_b32 s49, s2, 7
    s_lshr_b32 s50, s2, 3
    s_and_b32 s50, s50, 3
    s_lshr_b32 s51, s2, 5
    v_readfirstlane_b32 s48, v1
    s_lshl_b32 s52, s51, 3
    s_add_u32 s52, s52, s49
    s_mov_b32 s80, 0xfffff000
    s_waitcnt lgkmcnt(0)
    s_mov_b32 s28, s18
    s_mov_b32 s29, s19
    s_mov_b32 s30, 268435456
    s_mov_b32 s31, 0x00020000
    s_lshl_b32 s54, s51, 7
    v_mov_b32 v1, s54
    buffer_load_dword v255, v1, s[28:31], 0 offen sc1
    s_cmp_ge_u32 s48, 4
    s_cbranch_scc1 HELPER
    s_setprio 3
    s_lshl_b32 s54, s52, 20
    s_lshr_b32 s55, s52, 12
    s_lshl_b32 s56, s50, 18
    s_add_u32 s54, s54, s56
    s_add_u32 s20, s6, s54
    s_addc_u32 s21, s7, s55
    s_mov_b32 s22, 0x40000
    s_mov_b32 s23, 0x00020000
    s_add_u32 s24, s8, s54
    s_addc_u32 s25, s9, s55
    s_mov_b32 s26, 0x40000
    s_mov_b32 s27, 0x00020000
    s_lshl_b32 s60, s48, 15
    v_lshrrev_b32 v24, 5, v0
    v_and_b32 v25, 31, v0
    s_lshl_b32 s54, s48, 10
    v_add_u32 v26, 0, v24
    v_xor_b32 v26, v25, v26
    v_lshlrev_b32 v26, 4, v26
    v_lshl_add_u32 v26, v24, 9, v26
    v_add_u32 v2, s54, v26
    v_add_u32 v26, 2, v24
    v_xor_b32 v26, v25, v26
    v_lshlrev_b32 v26, 4, v26
    v_lshl_add_u32 v26, v24, 9, v26
    v_add_u32 v3, s54, v26
    v_add_u32 v26, 4, v24
    v_xor_b32 v26, v25, v26
    v_lshlrev_b32 v26, 4, v26
    v_lshl_add_u32 v26, v24, 9, v26
    v_add_u32 v4, s54, v26
    v_add_u32 v26, 6, v24
    v_xor_b32 v26, v25, v26
    v_lshlrev_b32 v26, 4, v26
    v_lshl_add_u32 v26, v24, 9, v26
    v_add_u32 v5, s54, v26
    v_add_u32 v26, 8, v24
    v_xor_b32 v26, v25, v26
    v_lshlrev_b32 v26, 4, v26
    v_lshl_add_u32 v26, v24, 9, v26
    v_add_u32 v6, s54, v26
    v_add_u32 v26, 10, v24
    v_xor_b32 v26, v25, v26
    v_lshlrev_b32 v26, 4, v26
    v_lshl_add_u32 v26, v24, 9, v26
    v_add_u32 v7, s54, v26
    v_add_u32 v26, 12, v24
    v_xor_b32 v26, v25, v26
    v_lshlrev_b32 v26, 4, v26
    v_lshl_add_u32 v26, v24, 9, v26
    v_add_u32 v8, s54, v26
    v_add_u32 v26, 14, v24
    v_xor_b32 v26, v25, v26
    v_lshlrev_b32 v26, 4, v26
    v_lshl_add_u32 v26, v24, 9, v26
    v_add_u32 v9, s54, v26
    s_add_u32 m0, s60, 0
    s_mov_b32 s61, 0
    buffer_load_dwordx4 v2, s[20:23], s61 offen nt lds
    s_add_u32 m0, s60, 1024
    s_mov_b32 s61, 4096
    buffer_load_dwordx4 v3, s[20:23], s61 offen nt lds
    s_add_u32 m0, s60, 2048
    s_mov_b32 s61, 8192
    buffer_load_dwordx4 v4, s[20:23], s61 offen nt lds
    s_add_u32 m0, s60, 3072
    s_mov_b32 s61, 12288
    buffer_load_dwordx4 v5, s[20:23], s61 offen nt lds
    s_add_u32 m0, s60, 4096
    s_mov_b32 s61, 16384
    buffer_load_dwordx4 v6, s[20:23], s61 offen nt lds
    s_add_u32 m0, s60, 5120
    s_mov_b32 s61, 20480
    buffer_load_dwordx4 v7, s[20:23], s61 offen nt lds
    s_add_u32 m0, s60, 6144
    s_mov_b32 s61, 24576
    buffer_load_dwordx4 v8, s[20:23], s61 offen nt lds
    s_add_u32 m0, s60, 7168
    s_mov_b32 s61, 28672
    buffer_load_dwordx4 v9, s[20:23], s61 offen nt lds
    s_barrier
    v_add_u32 v26, 0, v24
    v_and_b32 v27, 15, v25
    v_xor_b32 v26, v26, v27
    v_lshlrev_b32 v26, 4, v26
    v_lshl_add_u32 v26, v25, 9, v26
    v_add_u32 v10, s60, v26
    v_add_u32 v26, 2, v24
    v_and_b32 v27, 15, v25
    v_xor_b32 v26, v26, v27
    v_lshlrev_b32 v26, 4, v26
    v_lshl_add_u32 v26, v25, 9, v26
    v_add_u32 v11, s60, v26
    v_add_u32 v26, 4, v24
    v_and_b32 v27, 15, v25
    v_xor_b32 v26, v26, v27
    v_lshlrev_b32 v26, 4, v26
    v_lshl_add_u32 v26, v25, 9, v26
    v_add_u32 v12, s60, v26
    v_add_u32 v26, 6, v24
    v_and_b32 v27, 15, v25
    v_xor_b32 v26, v26, v27
    v_lshlrev_b32 v26, 4, v26
    v_lshl_add_u32 v26, v25, 9, v26
    v_add_u32 v13, s60, v26
    v_add_u32 v26, 8, v24
    v_and_b32 v27, 15, v25
    v_xor_b32 v26, v26, v27
    v_lshlrev_b32 v26, 4, v26
    v_lshl_add_u32 v26, v25, 9, v26
    v_add_u32 v14, s60, v26
    v_add_u32 v26, 10, v24
    v_and_b32 v27, 15, v25
    v_xor_b32 v26, v26, v27
    v_lshlrev_b32 v26, 4, v26
    v_lshl_add_u32 v26, v25, 9, v26
    v_add_u32 v15, s60, v26
    v_add_u32 v26, 12, v24
    v_and_b32 v27, 15, v25
    v_xor_b32 v26, v26, v27
    v_lshlrev_b32 v26, 4, v26
    v_lshl_add_u32 v26, v25, 9, v26
    v_add_u32 v16, s60, v26
    v_add_u32 v26, 14, v24
    v_and_b32 v27, 15, v25
    v_xor_b32 v26, v26, v27
    v_lshlrev_b32 v26, 4, v26
    v_lshl_add_u32 v26, v25, 9, v26
    v_add_u32 v17, s60, v26
    v_lshrrev_b32 v26, 3, v0
    v_and_b32 v27, 7, v0
    s_lshl_b32 s54, s48, 7
    v_lshlrev_b32 v26, 9, v26
    v_add_u32 v26, s54, v26
    v_lshl_add_u32 v18, v27, 4, v26
    v_xor_b32 v27, 4, v27
    v_lshl_add_u32 v19, v27, 4, v26
    v_and_b32 v26, 3, v0
    v_lshlrev_b32 v26, 3, v26
    v_bfe_u32 v27, v0, 4, 1
    v_lshl_add_u32 v26, v27, 5, v26
    v_lshl_add_u32 v26, v24, 11, v26
    v_bfe_u32 v27, v0, 2, 1
    v_lshl_add_u32 v26, v27, 7, v26
    v_bfe_u32 v27, v0, 3, 1
    v_lshl_add_u32 v26, v27, 10, v26
    v_add_u32 v26, s60, v26
    v_lshl_add_u32 v20, v27, 6, v26
    v_xor_b32 v27, 1, v27
    v_lshl_add_u32 v21, v27, 6, v26
    v_lshlrev_b32 v22, 4, v0
    v_add_u32 v22, 131072, v22
    s_lshl_b32 s54, s48, 10
    v_add_u32 v23, s54, v22
    s_waitcnt vmcnt(7)
    s_add_u32 m0, s60, 8192
    s_mov_b32 s61, 32768
    buffer_load_dwordx4 v2, s[20:23], s61 offen nt lds
    s_waitcnt vmcnt(7)
    s_add_u32 m0, s60, 9216
    s_mov_b32 s61, 36864
    buffer_load_dwordx4 v3, s[20:23], s61 offen nt lds
    s_waitcnt vmcnt(7)
    s_add_u32 m0, s60, 10240
    s_mov_b32 s61, 40960
    buffer_load_dwordx4 v4, s[20:23], s61 offen nt lds
    s_waitcnt vmcnt(7)
    s_add_u32 m0, s60, 11264
    s_mov_b32 s61, 45056
    buffer_load_dwordx4 v5, s[20:23], s61 offen nt lds
    s_waitcnt vmcnt(7)
    s_add_u32 m0, s60, 12288
    s_mov_b32 s61, 49152
    buffer_load_dwordx4 v6, s[20:23], s61 offen nt lds
    s_waitcnt vmcnt(7)
    s_add_u32 m0, s60, 13312
    s_mov_b32 s61, 53248
    buffer_load_dwordx4 v7, s[20:23], s61 offen nt lds
    s_waitcnt vmcnt(7)
    s_add_u32 m0, s60, 14336
    s_mov_b32 s61, 57344
    buffer_load_dwordx4 v8, s[20:23], s61 offen nt lds
    s_waitcnt vmcnt(7)
    s_add_u32 m0, s60, 15360
    s_mov_b32 s61, 61440
    buffer_load_dwordx4 v9, s[20:23], s61 offen nt lds
    s_waitcnt vmcnt(7)
    s_add_u32 m0, s60, 16384
    s_mov_b32 s61, 65536
    buffer_load_dwordx4 v2, s[20:23], s61 offen nt lds
    s_waitcnt vmcnt(7)
    s_add_u32 m0, s60, 17408
    s_mov_b32 s61, 69632
    buffer_load_dwordx4 v3, s[20:23], s61 offen nt lds
    s_waitcnt vmcnt(7)
    s_add_u32 m0, s60, 18432
    s_mov_b32 s61, 73728
    buffer_load_dwordx4 v4, s[20:23], s61 offen nt lds
    s_waitcnt vmcnt(7)
    s_add_u32 m0, s60, 19456
    s_mov_b32 s61, 77824
    buffer_load_dwordx4 v5, s[20:23], s61 offen nt lds
    s_waitcnt vmcnt(7)
    s_add_u32 m0, s60, 20480
    s_mov_b32 s61, 81920
    buffer_load_dwordx4 v6, s[20:23], s61 offen nt lds
    s_waitcnt vmcnt(7)
    s_add_u32 m0, s60, 21504
    s_mov_b32 s61, 86016
    buffer_load_dwordx4 v7, s[20:23], s61 offen nt lds
    s_waitcnt vmcnt(7)
    s_add_u32 m0, s60, 22528
    s_mov_b32 s61, 90112
    buffer_load_dwordx4 v8, s[20:23], s61 offen nt lds
    s_waitcnt vmcnt(7)
    ds_read_b128 v[176:179], v10 offset:0
    ds_read_b128 v[180:183], v11 offset:0
    ds_read_b128 v[184:187], v12 offset:0
    ds_read_b128 v[188:191], v13 offset:0
    ds_read_b128 v[192:195], v14 offset:0
    ds_read_b128 v[196:199], v15 offset:0
    ds_read_b128 v[200:203], v16 offset:0
    ds_read_b128 v[204:207], v17 offset:0
    ds_read_b128 v[208:211], v10 offset:256
    ds_read_b128 v[212:215], v11 offset:256
    ds_read_b128 v[216:219], v12 offset:256
    ds_read_b128 v[220:223], v13 offset:256
    ds_read_b128 v[224:227], v14 offset:256
    ds_read_b128 v[228:231], v15 offset:256
    ds_read_b128 v[232:235], v16 offset:256
    ds_read_b128 v[236:239], v17 offset:256
    s_waitcnt vmcnt(7)
    s_add_u32 m0, s60, 23552
    s_mov_b32 s61, 94208
    buffer_load_dwordx4 v9, s[20:23], s61 offen nt lds
    s_waitcnt vmcnt(7)
    s_add_u32 m0, s60, 24576
    s_mov_b32 s61, 98304
    buffer_load_dwordx4 v2, s[20:23], s61 offen nt lds
    s_waitcnt lgkmcnt(0)
    s_waitcnt vmcnt(7)
    s_add_u32 m0, s60, 25600
    s_mov_b32 s61, 102400
    buffer_load_dwordx4 v3, s[20:23], s61 offen nt lds
    s_waitcnt vmcnt(7)
    s_add_u32 m0, s60, 26624
    s_mov_b32 s61, 106496
    buffer_load_dwordx4 v4, s[20:23], s61 offen nt lds
    s_waitcnt vmcnt(7)
    s_add_u32 m0, s60, 27648
    s_mov_b32 s61, 110592
    buffer_load_dwordx4 v5, s[20:23], s61 offen nt lds
    s_waitcnt vmcnt(7)
    s_add_u32 m0, s60, 28672
    s_mov_b32 s61, 114688
    buffer_load_dwordx4 v6, s[20:23], s61 offen nt lds
    s_waitcnt vmcnt(7)
    s_add_u32 m0, s60, 29696
    s_mov_b32 s61, 118784
    buffer_load_dwordx4 v7, s[20:23], s61 offen nt lds
    s_waitcnt vmcnt(7)
    s_add_u32 m0, s60, 30720
    s_mov_b32 s61, 122880
    buffer_load_dwordx4 v8, s[20:23], s61 offen nt lds
    s_waitcnt vmcnt(7)
    s_add_u32 m0, s60, 31744
    s_mov_b32 s61, 126976
    buffer_load_dwordx4 v9, s[20:23], s61 offen nt lds
    s_waitcnt vmcnt(7)
    s_add_u32 m0, s60, 0
    s_mov_b32 s61, 131072
    buffer_load_dwordx4 v2, s[20:23], s61 offen nt lds
    s_waitcnt vmcnt(7)
    s_add_u32 m0, s60, 1024
    s_mov_b32 s61, 135168
    buffer_load_dwordx4 v3, s[20:23], s61 offen nt lds
    s_waitcnt vmcnt(7)
    s_add_u32 m0, s60, 2048
    s_mov_b32 s61, 139264
    buffer_load_dwordx4 v4, s[20:23], s61 offen nt lds
    s_waitcnt vmcnt(7)
    s_add_u32 m0, s60, 3072
    s_mov_b32 s61, 143360
    buffer_load_dwordx4 v5, s[20:23], s61 offen nt lds
    s_waitcnt vmcnt(7)
    s_add_u32 m0, s60, 4096
    s_mov_b32 s61, 147456
    buffer_load_dwordx4 v6, s[20:23], s61 offen nt lds
    s_waitcnt vmcnt(7)
    s_add_u32 m0, s60, 5120
    s_mov_b32 s61, 151552
    buffer_load_dwordx4 v7, s[20:23], s61 offen nt lds
    s_waitcnt vmcnt(7)
    s_add_u32 m0, s60, 6144
    s_mov_b32 s61, 155648
    buffer_load_dwordx4 v8, s[20:23], s61 offen nt lds
    s_waitcnt vmcnt(7)
    ds_read_b128 v[96:99], v10 offset:16384
    ds_read_b128 v[100:103], v11 offset:16384
    ds_read_b128 v[104:107], v12 offset:16384
    ds_read_b128 v[108:111], v13 offset:16384
    ds_read_b128 v[112:115], v14 offset:16384
    ds_read_b128 v[116:119], v15 offset:16384
    ds_read_b128 v[120:123], v16 offset:16384
    ds_read_b128 v[124:127], v17 offset:16384
    ds_read_b128 v[128:131], v10 offset:16640
    ds_read_b128 v[132:135], v11 offset:16640
    ds_read_b128 v[136:139], v12 offset:16640
    ds_read_b128 v[140:143], v13 offset:16640
    ds_read_b128 v[144:147], v14 offset:16640
    ds_read_b128 v[148:151], v15 offset:16640
    ds_read_b128 v[152:155], v16 offset:16640
    ds_read_b128 v[156:159], v17 offset:16640
    s_waitcnt lgkmcnt(0)
    s_waitcnt vmcnt(7)
    s_add_u32 m0, s60, 7168
    s_mov_b32 s61, 159744
    buffer_load_dwordx4 v9, s[20:23], s61 offen nt lds
    s_waitcnt vmcnt(7)
    s_add_u32 m0, s60, 8192
    s_mov_b32 s61, 163840
    buffer_load_dwordx4 v2, s[20:23], s61 offen nt lds
    s_waitcnt vmcnt(7)
    s_add_u32 m0, s60, 9216
    s_mov_b32 s61, 167936
    buffer_load_dwordx4 v3, s[20:23], s61 offen nt lds
    s_waitcnt vmcnt(7)
    s_add_u32 m0, s60, 10240
    s_mov_b32 s61, 172032
    buffer_load_dwordx4 v4, s[20:23], s61 offen nt lds
    s_waitcnt vmcnt(7)
    s_add_u32 m0, s60, 11264
    s_mov_b32 s61, 176128
    buffer_load_dwordx4 v5, s[20:23], s61 offen nt lds
    s_waitcnt vmcnt(7)
    s_add_u32 m0, s60, 12288
    s_mov_b32 s61, 180224
    buffer_load_dwordx4 v6, s[20:23], s61 offen nt lds
    s_waitcnt vmcnt(7)
    s_add_u32 m0, s60, 13312
    s_mov_b32 s61, 184320
    buffer_load_dwordx4 v7, s[20:23], s61 offen nt lds
    s_waitcnt vmcnt(7)
    s_add_u32 m0, s60, 14336
    s_mov_b32 s61, 188416
    buffer_load_dwordx4 v8, s[20:23], s61 offen nt lds
    s_waitcnt vmcnt(7)
    s_add_u32 m0, s60, 15360
    s_mov_b32 s61, 192512
    buffer_load_dwordx4 v9, s[20:23], s61 offen nt lds
    s_waitcnt vmcnt(7)
    s_add_u32 m0, s60, 16384
    s_mov_b32 s61, 196608
    buffer_load_dwordx4 v2, s[20:23], s61 offen nt lds
    s_waitcnt vmcnt(7)
    s_add_u32 m0, s60, 17408
    s_mov_b32 s61, 200704
    buffer_load_dwordx4 v3, s[20:23], s61 offen nt lds
    s_waitcnt vmcnt(7)
    s_add_u32 m0, s60, 18432
    s_mov_b32 s61, 204800
    buffer_load_dwordx4 v4, s[20:23], s61 offen nt lds
    s_waitcnt vmcnt(7)
    s_add_u32 m0, s60, 19456
    s_mov_b32 s61, 208896
    buffer_load_dwordx4 v5, s[20:23], s61 offen nt lds
    s_waitcnt vmcnt(7)
    s_add_u32 m0, s60, 20480
    s_mov_b32 s61, 212992
    buffer_load_dwordx4 v6, s[20:23], s61 offen nt lds
    s_waitcnt vmcnt(7)
    s_add_u32 m0, s60, 21504
    s_mov_b32 s61, 217088
    buffer_load_dwordx4 v7, s[20:23], s61 offen nt lds
    s_waitcnt vmcnt(7)
    s_add_u32 m0, s60, 22528
    s_mov_b32 s61, 221184
    buffer_load_dwordx4 v8, s[20:23], s61 offen nt lds
    s_waitcnt vmcnt(7)
    s_add_u32 m0, s60, 23552
    s_mov_b32 s61, 225280
    buffer_load_dwordx4 v9, s[20:23], s61 offen nt lds
    s_waitcnt vmcnt(7)
    s_add_u32 m0, s60, 24576
    s_mov_b32 s61, 229376
    buffer_load_dwordx4 v2, s[20:23], s61 offen nt lds
    s_waitcnt vmcnt(7)
    s_add_u32 m0, s60, 25600
    s_mov_b32 s61, 233472
    buffer_load_dwordx4 v3, s[20:23], s61 offen nt lds
    s_waitcnt vmcnt(7)
    s_add_u32 m0, s60, 26624
    s_mov_b32 s61, 237568
    buffer_load_dwordx4 v4, s[20:23], s61 offen nt lds
    s_waitcnt vmcnt(7)
    s_add_u32 m0, s60, 27648
    s_mov_b32 s61, 241664
    buffer_load_dwordx4 v5, s[20:23], s61 offen nt lds
    s_waitcnt vmcnt(7)
    s_add_u32 m0, s60, 28672
    s_mov_b32 s61, 245760
    buffer_load_dwordx4 v6, s[20:23], s61 offen nt lds
    s_waitcnt vmcnt(7)
    s_add_u32 m0, s60, 29696
    s_mov_b32 s61, 249856
    buffer_load_dwordx4 v7, s[20:23], s61 offen nt lds
    s_waitcnt vmcnt(7)
    s_add_u32 m0, s60, 30720
    s_mov_b32 s61, 253952
    buffer_load_dwordx4 v8, s[20:23], s61 offen nt lds
    s_waitcnt vmcnt(7)
    s_add_u32 m0, s60, 31744
    s_mov_b32 s61, 258048
    buffer_load_dwordx4 v9, s[20:23], s61 offen nt lds
    s_barrier
    ds_read_b128 v[32:35], v22 offset:0
    ds_read_b128 v[36:39], v22 offset:1024
    ds_read_b128 v[40:43], v22 offset:2048
    ds_read_b128 v[44:47], v22 offset:3072
    ds_read_b128 v[48:51], v22 offset:4096
    ds_read_b128 v[52:55], v22 offset:5120
    ds_read_b128 v[56:59], v22 offset:6144
    ds_read_b128 v[60:63], v22 offset:7168
    ds_read_b128 v[64:67], v22 offset:8192
    ds_read_b128 v[68:71], v22 offset:9216
    ds_read_b128 v[72:75], v22 offset:10240
    ds_read_b128 v[76:79], v22 offset:11264
    ds_read_b128 v[80:83], v22 offset:12288
    ds_read_b128 v[84:87], v22 offset:13312
    ds_read_b128 v[88:91], v22 offset:14336
    ds_read_b128 v[92:95], v22 offset:15360
    s_waitcnt lgkmcnt(15)
    v_mfma_f32_32x32x16_bf16 v[160:175], v[96:99], v[32:35], 0
    s_waitcnt lgkmcnt(14)
    v_mfma_f32_32x32x16_bf16 v[160:175], v[100:103], v[36:39], v[160:175]
    s_waitcnt lgkmcnt(13)
    v_mfma_f32_32x32x16_bf16 v[160:175], v[104:107], v[40:43], v[160:175]
    s_waitcnt lgkmcnt(12)
    v_mfma_f32_32x32x16_bf16 v[160:175], v[108:111], v[44:47], v[160:175]
    s_waitcnt lgkmcnt(11)
    v_mfma_f32_32x32x16_bf16 v[160:175], v[112:115], v[48:51], v[160:175]
    s_waitcnt lgkmcnt(10)
    v_mfma_f32_32x32x16_bf16 v[160:175], v[116:119], v[52:55], v[160:175]
    s_waitcnt lgkmcnt(9)
    v_mfma_f32_32x32x16_bf16 v[160:175], v[120:123], v[56:59], v[160:175]
    s_waitcnt lgkmcnt(8)
    v_mfma_f32_32x32x16_bf16 v[160:175], v[124:127], v[60:63], v[160:175]
    s_waitcnt lgkmcnt(7)
    v_mfma_f32_32x32x16_bf16 v[160:175], v[128:131], v[64:67], v[160:175]
    s_waitcnt lgkmcnt(6)
    v_mfma_f32_32x32x16_bf16 v[160:175], v[132:135], v[68:71], v[160:175]
    s_waitcnt lgkmcnt(5)
    v_mfma_f32_32x32x16_bf16 v[160:175], v[136:139], v[72:75], v[160:175]
    s_waitcnt lgkmcnt(4)
    v_mfma_f32_32x32x16_bf16 v[160:175], v[140:143], v[76:79], v[160:175]
    s_waitcnt lgkmcnt(3)
    v_mfma_f32_32x32x16_bf16 v[160:175], v[144:147], v[80:83], v[160:175]
    s_waitcnt lgkmcnt(2)
    v_mfma_f32_32x32x16_bf16 v[160:175], v[148:151], v[84:87], v[160:175]
    s_waitcnt lgkmcnt(1)
    v_mfma_f32_32x32x16_bf16 v[160:175], v[152:155], v[88:91], v[160:175]
    s_waitcnt lgkmcnt(0)
    v_mfma_f32_32x32x16_bf16 v[160:175], v[156:159], v[92:95], v[160:175]
    v_mfma_f32_32x32x16_bf16 v[128:143], v[176:179], v[32:35], 0
    v_mfma_f32_32x32x16_bf16 v[128:143], v[180:183], v[36:39], v[128:143]
    v_mfma_f32_32x32x16_bf16 v[128:143], v[184:187], v[40:43], v[128:143]
    v_mfma_f32_32x32x16_bf16 v[128:143], v[188:191], v[44:47], v[128:143]
    v_mfma_f32_32x32x16_bf16 v[128:143], v[192:195], v[48:51], v[128:143]
    v_mfma_f32_32x32x16_bf16 v[128:143], v[196:199], v[52:55], v[128:143]
    v_mfma_f32_32x32x16_bf16 v[128:143], v[200:203], v[56:59], v[128:143]
    v_mfma_f32_32x32x16_bf16 v[128:143], v[204:207], v[60:63], v[128:143]
    v_mfma_f32_32x32x16_bf16 v[128:143], v[208:211], v[64:67], v[128:143]
    v_mfma_f32_32x32x16_bf16 v[128:143], v[212:215], v[68:71], v[128:143]
    v_mfma_f32_32x32x16_bf16 v[128:143], v[216:219], v[72:75], v[128:143]
    v_mfma_f32_32x32x16_bf16 v[128:143], v[220:223], v[76:79], v[128:143]
    v_mfma_f32_32x32x16_bf16 v[128:143], v[224:227], v[80:83], v[128:143]
    v_mfma_f32_32x32x16_bf16 v[128:143], v[228:231], v[84:87], v[128:143]
    v_mfma_f32_32x32x16_bf16 v[128:143], v[232:235], v[88:91], v[128:143]
    v_mfma_f32_32x32x16_bf16 v[128:143], v[236:239], v[92:95], v[128:143]
    s_waitcnt vmcnt(16)
    ds_read_b128 v[144:147], v10 offset:0
    ds_read_b128 v[148:151], v11 offset:0
    ds_read_b128 v[152:155], v12 offset:0
    ds_read_b128 v[156:159], v13 offset:0
    s_waitcnt lgkmcnt(3)
    v_mfma_f32_32x32x16_bf16 v[96:111], v[144:147], v[32:35], 0
    ds_read_b128 v[144:147], v14 offset:0
    s_waitcnt lgkmcnt(3)
    v_mfma_f32_32x32x16_bf16 v[96:111], v[148:151], v[36:39], v[96:111]
    ds_read_b128 v[148:151], v15 offset:0
    s_waitcnt lgkmcnt(3)
    v_mfma_f32_32x32x16_bf16 v[96:111], v[152:155], v[40:43], v[96:111]
    ds_read_b128 v[152:155], v16 offset:0
    s_waitcnt lgkmcnt(3)
    v_mfma_f32_32x32x16_bf16 v[96:111], v[156:159], v[44:47], v[96:111]
    ds_read_b128 v[156:159], v17 offset:0
    s_waitcnt lgkmcnt(3)
    v_mfma_f32_32x32x16_bf16 v[96:111], v[144:147], v[48:51], v[96:111]
    ds_read_b128 v[144:147], v10 offset:256
    s_waitcnt lgkmcnt(3)
    v_mfma_f32_32x32x16_bf16 v[96:111], v[148:151], v[52:55], v[96:111]
    ds_read_b128 v[148:151], v11 offset:256
    s_waitcnt lgkmcnt(3)
    v_mfma_f32_32x32x16_bf16 v[96:111], v[152:155], v[56:59], v[96:111]
    ds_read_b128 v[152:155], v12 offset:256
    s_waitcnt lgkmcnt(3)
    v_mfma_f32_32x32x16_bf16 v[96:111], v[156:159], v[60:63], v[96:111]
    ds_read_b128 v[156:159], v13 offset:256
    s_waitcnt lgkmcnt(3)
    v_mfma_f32_32x32x16_bf16 v[96:111], v[144:147], v[64:67], v[96:111]
    ds_read_b128 v[144:147], v14 offset:256
    s_waitcnt lgkmcnt(3)
    v_mfma_f32_32x32x16_bf16 v[96:111], v[148:151], v[68:71], v[96:111]
    ds_read_b128 v[148:151], v15 offset:256
    s_waitcnt lgkmcnt(3)
    v_mfma_f32_32x32x16_bf16 v[96:111], v[152:155], v[72:75], v[96:111]
    ds_read_b128 v[152:155], v16 offset:256
    s_waitcnt lgkmcnt(3)
    v_mfma_f32_32x32x16_bf16 v[96:111], v[156:159], v[76:79], v[96:111]
    ds_read_b128 v[156:159], v17 offset:256
    s_waitcnt lgkmcnt(3)
    v_mfma_f32_32x32x16_bf16 v[96:111], v[144:147], v[80:83], v[96:111]
    s_waitcnt lgkmcnt(2)
    v_mfma_f32_32x32x16_bf16 v[96:111], v[148:151], v[84:87], v[96:111]
    s_waitcnt lgkmcnt(1)
    v_mfma_f32_32x32x16_bf16 v[96:111], v[152:155], v[88:91], v[96:111]
    s_waitcnt lgkmcnt(0)
    v_mfma_f32_32x32x16_bf16 v[96:111], v[156:159], v[92:95], v[96:111]
    s_waitcnt vmcnt(7)
    s_add_u32 m0, s60, 0
    s_mov_b32 s61, 0
    buffer_load_dwordx4 v18, s[24:27], s61 offen nt lds
    s_waitcnt vmcnt(7)
    s_add_u32 m0, s60, 1024
    s_mov_b32 s61, 4096
    buffer_load_dwordx4 v19, s[24:27], s61 offen nt lds
    s_add_u32 m0, s60, 2048
    s_mov_b32 s61, 8192
    buffer_load_dwordx4 v18, s[24:27], s61 offen nt lds
    s_add_u32 m0, s60, 3072
    s_mov_b32 s61, 12288
    buffer_load_dwordx4 v19, s[24:27], s61 offen nt lds
    s_add_u32 m0, s60, 4096
    s_mov_b32 s61, 16384
    buffer_load_dwordx4 v18, s[24:27], s61 offen nt lds
    s_add_u32 m0, s60, 5120
    s_mov_b32 s61, 20480
    buffer_load_dwordx4 v19, s[24:27], s61 offen nt lds
    s_add_u32 m0, s60, 6144
    s_mov_b32 s61, 24576
    buffer_load_dwordx4 v18, s[24:27], s61 offen nt lds
    s_waitcnt vmcnt(7)
    ds_read_b128 v[144:147], v10 offset:16384
    ds_read_b128 v[148:151], v11 offset:16384
    ds_read_b128 v[152:155], v12 offset:16384
    ds_read_b128 v[156:159], v13 offset:16384
    s_waitcnt lgkmcnt(3)
    v_mfma_f32_32x32x16_bf16 v[112:127], v[144:147], v[32:35], 0
    ds_read_b128 v[144:147], v14 offset:16384
    s_waitcnt lgkmcnt(3)
    v_mfma_f32_32x32x16_bf16 v[112:127], v[148:151], v[36:39], v[112:127]
    ds_read_b128 v[148:151], v15 offset:16384
    s_waitcnt lgkmcnt(3)
    v_mfma_f32_32x32x16_bf16 v[112:127], v[152:155], v[40:43], v[112:127]
    ds_read_b128 v[152:155], v16 offset:16384
    s_waitcnt lgkmcnt(3)
    v_mfma_f32_32x32x16_bf16 v[112:127], v[156:159], v[44:47], v[112:127]
    s_add_u32 m0, s60, 7168
    s_mov_b32 s61, 28672
    buffer_load_dwordx4 v19, s[24:27], s61 offen nt lds
    ds_read_b128 v[156:159], v17 offset:16384
    s_waitcnt lgkmcnt(3)
    v_mfma_f32_32x32x16_bf16 v[112:127], v[144:147], v[48:51], v[112:127]
    ds_read_b128 v[144:147], v10 offset:16640
    s_waitcnt lgkmcnt(3)
    v_mfma_f32_32x32x16_bf16 v[112:127], v[148:151], v[52:55], v[112:127]
    ds_read_b128 v[148:151], v11 offset:16640
    s_waitcnt lgkmcnt(3)
    v_mfma_f32_32x32x16_bf16 v[112:127], v[152:155], v[56:59], v[112:127]
    ds_read_b128 v[152:155], v12 offset:16640
    s_waitcnt lgkmcnt(3)
    v_mfma_f32_32x32x16_bf16 v[112:127], v[156:159], v[60:63], v[112:127]
    s_add_u32 m0, s60, 8192
    s_mov_b32 s61, 32768
    buffer_load_dwordx4 v18, s[24:27], s61 offen nt lds
    ds_read_b128 v[156:159], v13 offset:16640
    s_waitcnt lgkmcnt(3)
    v_mfma_f32_32x32x16_bf16 v[112:127], v[144:147], v[64:67], v[112:127]
    ds_read_b128 v[144:147], v14 offset:16640
    s_waitcnt lgkmcnt(3)
    v_mfma_f32_32x32x16_bf16 v[112:127], v[148:151], v[68:71], v[112:127]
    ds_read_b128 v[148:151], v15 offset:16640
    s_waitcnt lgkmcnt(3)
    v_mfma_f32_32x32x16_bf16 v[112:127], v[152:155], v[72:75], v[112:127]
    ds_read_b128 v[152:155], v16 offset:16640
    s_waitcnt lgkmcnt(3)
    v_mfma_f32_32x32x16_bf16 v[112:127], v[156:159], v[76:79], v[112:127]
    s_add_u32 m0, s60, 9216
    s_mov_b32 s61, 36864
    buffer_load_dwordx4 v19, s[24:27], s61 offen nt lds
    ds_read_b128 v[156:159], v17 offset:16640
    s_waitcnt lgkmcnt(3)
    v_mfma_f32_32x32x16_bf16 v[112:127], v[144:147], v[80:83], v[112:127]
    s_waitcnt lgkmcnt(2)
    v_mfma_f32_32x32x16_bf16 v[112:127], v[148:151], v[84:87], v[112:127]
    s_waitcnt lgkmcnt(1)
    v_mfma_f32_32x32x16_bf16 v[112:127], v[152:155], v[88:91], v[112:127]
    s_waitcnt lgkmcnt(0)
    v_mfma_f32_32x32x16_bf16 v[112:127], v[156:159], v[92:95], v[112:127]
    s_add_u32 m0, s60, 10240
    s_mov_b32 s61, 40960
    buffer_load_dwordx4 v18, s[24:27], s61 offen nt lds
    s_nop 7
    s_nop 3
    v_max3_f32 v24, v128, v129, v130
    v_max3_f32 v24, v24, v131, v132
    v_max3_f32 v24, v24, v133, v134
    v_max3_f32 v24, v24, v135, v136
    v_max3_f32 v24, v24, v137, v138
    v_max3_f32 v24, v24, v139, v140
    v_max3_f32 v24, v24, v141, v142
    v_max3_f32 v24, v24, v143, v160
    s_add_u32 m0, s60, 11264
    s_mov_b32 s61, 45056
    buffer_load_dwordx4 v19, s[24:27], s61 offen nt lds
    v_max3_f32 v24, v24, v161, v162
    v_max3_f32 v24, v24, v163, v164
    v_max3_f32 v24, v24, v165, v166
    v_max3_f32 v24, v24, v167, v168
    v_max3_f32 v24, v24, v169, v170
    v_max3_f32 v24, v24, v171, v172
    v_max3_f32 v24, v24, v173, v174
    v_max3_f32 v24, v24, v175, v96
    s_add_u32 m0, s60, 12288
    s_mov_b32 s61, 49152
    buffer_load_dwordx4 v18, s[24:27], s61 offen nt lds
    v_max3_f32 v24, v24, v97, v98
    v_max3_f32 v24, v24, v99, v100
    v_max3_f32 v24, v24, v101, v102
    v_max3_f32 v24, v24, v103, v104
    v_max3_f32 v24, v24, v105, v106
    v_max3_f32 v24, v24, v107, v108
    v_max3_f32 v24, v24, v109, v110
    v_max3_f32 v24, v24, v111, v112
    s_add_u32 m0, s60, 13312
    s_mov_b32 s61, 53248
    buffer_load_dwordx4 v19, s[24:27], s61 offen nt lds
    v_max3_f32 v24, v24, v113, v114
    v_max3_f32 v24, v24, v115, v116
    v_max3_f32 v24, v24, v117, v118
    v_max3_f32 v24, v24, v119, v120
    v_max3_f32 v24, v24, v121, v122
    v_max3_f32 v24, v24, v123, v124
    v_max3_f32 v24, v24, v125, v126
    v_max_f32 v24, v24, v127
    v_mov_b32 v25, v24
    s_nop 1
    v_permlane32_swap_b32 v24, v25
    s_nop 1
    v_max_f32 v24, v24, v25
    v_and_b32 v26, 31, v0
    v_lshlrev_b32 v26, 2, v26
    v_add_u32 v27, s60, v26
    ds_write_b32 v27, v24 offset:24576
    s_waitcnt lgkmcnt(0)
    s_add_u32 m0, s60, 14336
    s_mov_b32 s61, 57344
    buffer_load_dwordx4 v18, s[24:27], s61 offen nt lds
    s_add_u32 m0, s60, 15360
    s_mov_b32 s61, 61440
    buffer_load_dwordx4 v19, s[24:27], s61 offen nt lds
    s_barrier
    v_add_u32 v1, 0x10000, v26
    ds_read_b32 v28, v26 offset:24576
    ds_read_b32 v29, v26 offset:57344
    ds_read_b32 v30, v1 offset:24576
    ds_read_b32 v31, v1 offset:57344
    s_mov_b32 s54, 0x3db8aa3b
    s_waitcnt lgkmcnt(0)
    v_max3_f32 v24, v28, v29, v30
    v_max_f32 v24, v24, v31
    v_mul_f32 v24, s54, v24
    v_mov_b32 v25, 0
    v_fma_f32 v128, v128, s54, -v24
    v_fma_f32 v129, v129, s54, -v24
    v_fma_f32 v130, v130, s54, -v24
    v_fma_f32 v131, v131, s54, -v24
    v_fma_f32 v132, v132, s54, -v24
    v_fma_f32 v133, v133, s54, -v24
    v_fma_f32 v134, v134, s54, -v24
    v_fma_f32 v135, v135, s54, -v24
    v_exp_f32 v128, v128
    v_exp_f32 v129, v129
    v_exp_f32 v130, v130
    v_exp_f32 v131, v131
    v_exp_f32 v132, v132
    v_exp_f32 v133, v133
    v_exp_f32 v134, v134
    v_exp_f32 v135, v135
    s_add_u32 m0, s60, 16384
    s_mov_b32 s61, 65536
    buffer_load_dwordx4 v18, s[24:27], s61 offen nt lds
    v_add_f32 v25, v25, v128
    v_add_f32 v25, v25, v129
    v_add_f32 v25, v25, v130
    v_add_f32 v25, v25, v131
    v_add_f32 v25, v25, v132
    v_add_f32 v25, v25, v133
    v_add_f32 v25, v25, v134
    v_add_f32 v25, v25, v135
    v_cvt_pk_bf16_f32 v176, v128, v129
    v_cvt_pk_bf16_f32 v177, v130, v131
    v_cvt_pk_bf16_f32 v178, v132, v133
    v_cvt_pk_bf16_f32 v179, v134, v135
    ds_write_b128 v23, v[176:179] offset:0
    v_fma_f32 v136, v136, s54, -v24
    v_fma_f32 v137, v137, s54, -v24
    v_fma_f32 v138, v138, s54, -v24
    v_fma_f32 v139, v139, s54, -v24
    v_fma_f32 v140, v140, s54, -v24
    v_fma_f32 v141, v141, s54, -v24
    v_fma_f32 v142, v142, s54, -v24
    v_fma_f32 v143, v143, s54, -v24
    v_exp_f32 v136, v136
    v_exp_f32 v137, v137
    v_exp_f32 v138, v138
    v_exp_f32 v139, v139
    v_exp_f32 v140, v140
    v_exp_f32 v141, v141
    v_exp_f32 v142, v142
    v_exp_f32 v143, v143
    s_add_u32 m0, s60, 17408
    s_mov_b32 s61, 69632
    buffer_load_dwordx4 v19, s[24:27], s61 offen nt lds
    v_add_f32 v25, v25, v136
    v_add_f32 v25, v25, v137
    v_add_f32 v25, v25, v138
    v_add_f32 v25, v25, v139
    v_add_f32 v25, v25, v140
    v_add_f32 v25, v25, v141
    v_add_f32 v25, v25, v142
    v_add_f32 v25, v25, v143
    v_cvt_pk_bf16_f32 v180, v136, v137
    v_cvt_pk_bf16_f32 v181, v138, v139
    v_cvt_pk_bf16_f32 v182, v140, v141
    v_cvt_pk_bf16_f32 v183, v142, v143
    ds_write_b128 v23, v[180:183] offset:4096
    v_fma_f32 v160, v160, s54, -v24
    v_fma_f32 v161, v161, s54, -v24
    v_fma_f32 v162, v162, s54, -v24
    v_fma_f32 v163, v163, s54, -v24
    v_fma_f32 v164, v164, s54, -v24
    v_fma_f32 v165, v165, s54, -v24
    v_fma_f32 v166, v166, s54, -v24
    v_fma_f32 v167, v167, s54, -v24
    v_exp_f32 v160, v160
    v_exp_f32 v161, v161
    v_exp_f32 v162, v162
    v_exp_f32 v163, v163
    v_exp_f32 v164, v164
    v_exp_f32 v165, v165
    v_exp_f32 v166, v166
    v_exp_f32 v167, v167
    s_add_u32 m0, s60, 18432
    s_mov_b32 s61, 73728
    buffer_load_dwordx4 v18, s[24:27], s61 offen nt lds
    v_add_f32 v25, v25, v160
    v_add_f32 v25, v25, v161
    v_add_f32 v25, v25, v162
    v_add_f32 v25, v25, v163
    v_add_f32 v25, v25, v164
    v_add_f32 v25, v25, v165
    v_add_f32 v25, v25, v166
    v_add_f32 v25, v25, v167
    v_cvt_pk_bf16_f32 v176, v160, v161
    v_cvt_pk_bf16_f32 v177, v162, v163
    v_cvt_pk_bf16_f32 v178, v164, v165
    v_cvt_pk_bf16_f32 v179, v166, v167
    ds_write_b128 v23, v[176:179] offset:8192
    v_fma_f32 v168, v168, s54, -v24
    v_fma_f32 v169, v169, s54, -v24
    v_fma_f32 v170, v170, s54, -v24
    v_fma_f32 v171, v171, s54, -v24
    v_fma_f32 v172, v172, s54, -v24
    v_fma_f32 v173, v173, s54, -v24
    v_fma_f32 v174, v174, s54, -v24
    v_fma_f32 v175, v175, s54, -v24
    v_exp_f32 v168, v168
    v_exp_f32 v169, v169
    v_exp_f32 v170, v170
    v_exp_f32 v171, v171
    v_exp_f32 v172, v172
    v_exp_f32 v173, v173
    v_exp_f32 v174, v174
    v_exp_f32 v175, v175
    s_add_u32 m0, s60, 19456
    s_mov_b32 s61, 77824
    buffer_load_dwordx4 v19, s[24:27], s61 offen nt lds
    v_add_f32 v25, v25, v168
    v_add_f32 v25, v25, v169
    v_add_f32 v25, v25, v170
    v_add_f32 v25, v25, v171
    v_add_f32 v25, v25, v172
    v_add_f32 v25, v25, v173
    v_add_f32 v25, v25, v174
    v_add_f32 v25, v25, v175
    v_cvt_pk_bf16_f32 v180, v168, v169
    v_cvt_pk_bf16_f32 v181, v170, v171
    v_cvt_pk_bf16_f32 v182, v172, v173
    v_cvt_pk_bf16_f32 v183, v174, v175
    ds_write_b128 v23, v[180:183] offset:12288
    v_fma_f32 v96, v96, s54, -v24
    v_fma_f32 v97, v97, s54, -v24
    v_fma_f32 v98, v98, s54, -v24
    v_fma_f32 v99, v99, s54, -v24
    v_fma_f32 v100, v100, s54, -v24
    v_fma_f32 v101, v101, s54, -v24
    v_fma_f32 v102, v102, s54, -v24
    v_fma_f32 v103, v103, s54, -v24
    v_exp_f32 v96, v96
    v_exp_f32 v97, v97
    v_exp_f32 v98, v98
    v_exp_f32 v99, v99
    v_exp_f32 v100, v100
    v_exp_f32 v101, v101
    v_exp_f32 v102, v102
    v_exp_f32 v103, v103
    s_add_u32 m0, s60, 20480
    s_mov_b32 s61, 81920
    buffer_load_dwordx4 v18, s[24:27], s61 offen nt lds
    v_add_f32 v25, v25, v96
    v_add_f32 v25, v25, v97
    v_add_f32 v25, v25, v98
    v_add_f32 v25, v25, v99
    v_add_f32 v25, v25, v100
    v_add_f32 v25, v25, v101
    v_add_f32 v25, v25, v102
    v_add_f32 v25, v25, v103
    v_cvt_pk_bf16_f32 v176, v96, v97
    v_cvt_pk_bf16_f32 v177, v98, v99
    v_cvt_pk_bf16_f32 v178, v100, v101
    v_cvt_pk_bf16_f32 v179, v102, v103
    ds_write_b128 v23, v[176:179] offset:16384
    v_fma_f32 v104, v104, s54, -v24
    v_fma_f32 v105, v105, s54, -v24
    v_fma_f32 v106, v106, s54, -v24
    v_fma_f32 v107, v107, s54, -v24
    v_fma_f32 v108, v108, s54, -v24
    v_fma_f32 v109, v109, s54, -v24
    v_fma_f32 v110, v110, s54, -v24
    v_fma_f32 v111, v111, s54, -v24
    v_exp_f32 v104, v104
    v_exp_f32 v105, v105
    v_exp_f32 v106, v106
    v_exp_f32 v107, v107
    v_exp_f32 v108, v108
    v_exp_f32 v109, v109
    v_exp_f32 v110, v110
    v_exp_f32 v111, v111
    s_add_u32 m0, s60, 21504
    s_mov_b32 s61, 86016
    buffer_load_dwordx4 v19, s[24:27], s61 offen nt lds
    v_add_f32 v25, v25, v104
    v_add_f32 v25, v25, v105
    v_add_f32 v25, v25, v106
    v_add_f32 v25, v25, v107
    v_add_f32 v25, v25, v108
    v_add_f32 v25, v25, v109
    v_add_f32 v25, v25, v110
    v_add_f32 v25, v25, v111
    v_cvt_pk_bf16_f32 v180, v104, v105
    v_cvt_pk_bf16_f32 v181, v106, v107
    v_cvt_pk_bf16_f32 v182, v108, v109
    v_cvt_pk_bf16_f32 v183, v110, v111
    ds_write_b128 v23, v[180:183] offset:20480
    v_fma_f32 v112, v112, s54, -v24
    v_fma_f32 v113, v113, s54, -v24
    v_fma_f32 v114, v114, s54, -v24
    v_fma_f32 v115, v115, s54, -v24
    v_fma_f32 v116, v116, s54, -v24
    v_fma_f32 v117, v117, s54, -v24
    v_fma_f32 v118, v118, s54, -v24
    v_fma_f32 v119, v119, s54, -v24
    v_exp_f32 v112, v112
    v_exp_f32 v113, v113
    v_exp_f32 v114, v114
    v_exp_f32 v115, v115
    v_exp_f32 v116, v116
    v_exp_f32 v117, v117
    v_exp_f32 v118, v118
    v_exp_f32 v119, v119
    s_add_u32 m0, s60, 22528
    s_mov_b32 s61, 90112
    buffer_load_dwordx4 v18, s[24:27], s61 offen nt lds
    v_add_f32 v25, v25, v112
    v_add_f32 v25, v25, v113
    v_add_f32 v25, v25, v114
    v_add_f32 v25, v25, v115
    v_add_f32 v25, v25, v116
    v_add_f32 v25, v25, v117
    v_add_f32 v25, v25, v118
    v_add_f32 v25, v25, v119
    v_cvt_pk_bf16_f32 v176, v112, v113
    v_cvt_pk_bf16_f32 v177, v114, v115
    v_cvt_pk_bf16_f32 v178, v116, v117
    v_cvt_pk_bf16_f32 v179, v118, v119
    ds_write_b128 v23, v[176:179] offset:24576
    v_fma_f32 v120, v120, s54, -v24
    v_fma_f32 v121, v121, s54, -v24
    v_fma_f32 v122, v122, s54, -v24
    v_fma_f32 v123, v123, s54, -v24
    v_fma_f32 v124, v124, s54, -v24
    v_fma_f32 v125, v125, s54, -v24
    v_fma_f32 v126, v126, s54, -v24
    v_fma_f32 v127, v127, s54, -v24
    v_exp_f32 v120, v120
    v_exp_f32 v121, v121
    v_exp_f32 v122, v122
    v_exp_f32 v123, v123
    v_exp_f32 v124, v124
    v_exp_f32 v125, v125
    v_exp_f32 v126, v126
    v_exp_f32 v127, v127
    s_add_u32 m0, s60, 23552
    s_mov_b32 s61, 94208
    buffer_load_dwordx4 v19, s[24:27], s61 offen nt lds
    v_add_f32 v25, v25, v120
    v_add_f32 v25, v25, v121
    v_add_f32 v25, v25, v122
    v_add_f32 v25, v25, v123
    v_add_f32 v25, v25, v124
    v_add_f32 v25, v25, v125
    v_add_f32 v25, v25, v126
    v_add_f32 v25, v25, v127
    v_cvt_pk_bf16_f32 v180, v120, v121
    v_cvt_pk_bf16_f32 v181, v122, v123
    v_cvt_pk_bf16_f32 v182, v124, v125
    v_cvt_pk_bf16_f32 v183, v126, v127
    ds_write_b128 v23, v[180:183] offset:28672
    v_mov_b32 v24, v25
    s_nop 1
    v_permlane32_swap_b32 v24, v25
    s_nop 1
    v_add_f32 v24, v24, v25
    ds_write_b32 v27, v24 offset:24704
    s_waitcnt lgkmcnt(0)
    s_barrier
    s_waitcnt vmcnt(16)
    ds_read_b128 v[32:35], v22 offset:0
    ds_read_b64_tr_b16 v[48:49], v20 offset:0
    ds_read_b64_tr_b16 v[50:51], v20 offset:4096
    ds_read_b64_tr_b16 v[52:53], v21 offset:0
    ds_read_b64_tr_b16 v[54:55], v21 offset:4096
    ds_read_b128 v[36:39], v22 offset:1024
    ds_read_b64_tr_b16 v[56:57], v20 offset:256
    ds_read_b64_tr_b16 v[58:59], v20 offset:4352
    ds_read_b64_tr_b16 v[60:61], v21 offset:256
    ds_read_b64_tr_b16 v[62:63], v21 offset:4352
    s_waitcnt lgkmcnt(5)
    v_mfma_f32_32x32x16_bf16 v[176:191], v[48:51], v[32:35], 0
    v_mfma_f32_32x32x16_bf16 v[192:207], v[52:55], v[32:35], 0
    ds_read_b128 v[32:35], v22 offset:2048
    ds_read_b64_tr_b16 v[48:49], v20 offset:512
    ds_read_b64_tr_b16 v[50:51], v20 offset:4608
    ds_read_b64_tr_b16 v[52:53], v21 offset:512
    ds_read_b64_tr_b16 v[54:55], v21 offset:4608
    s_waitcnt lgkmcnt(5)
    v_mfma_f32_32x32x16_bf16 v[176:191], v[56:59], v[36:39], v[176:191]
    v_mfma_f32_32x32x16_bf16 v[192:207], v[60:63], v[36:39], v[192:207]
    ds_read_b128 v[36:39], v22 offset:3072
    ds_read_b64_tr_b16 v[56:57], v20 offset:768
    ds_read_b64_tr_b16 v[58:59], v20 offset:4864
    ds_read_b64_tr_b16 v[60:61], v21 offset:768
    ds_read_b64_tr_b16 v[62:63], v21 offset:4864
    s_waitcnt lgkmcnt(5)
    v_mfma_f32_32x32x16_bf16 v[176:191], v[48:51], v[32:35], v[176:191]
    v_mfma_f32_32x32x16_bf16 v[192:207], v[52:55], v[32:35], v[192:207]
    s_waitcnt lgkmcnt(0)
    v_mfma_f32_32x32x16_bf16 v[176:191], v[56:59], v[36:39], v[176:191]
    v_mfma_f32_32x32x16_bf16 v[192:207], v[60:63], v[36:39], v[192:207]
    s_waitcnt vmcnt(8)
    ds_read_b128 v[32:35], v22 offset:4096
    ds_read_b64_tr_b16 v[48:49], v20 offset:8192
    ds_read_b64_tr_b16 v[50:51], v20 offset:12288
    ds_read_b64_tr_b16 v[52:53], v21 offset:8192
    ds_read_b64_tr_b16 v[54:55], v21 offset:12288
    ds_read_b128 v[36:39], v22 offset:5120
    ds_read_b64_tr_b16 v[56:57], v20 offset:8448
    ds_read_b64_tr_b16 v[58:59], v20 offset:12544
    ds_read_b64_tr_b16 v[60:61], v21 offset:8448
    ds_read_b64_tr_b16 v[62:63], v21 offset:12544
    s_waitcnt lgkmcnt(5)
    v_mfma_f32_32x32x16_bf16 v[176:191], v[48:51], v[32:35], v[176:191]
    v_mfma_f32_32x32x16_bf16 v[192:207], v[52:55], v[32:35], v[192:207]
    s_waitcnt vmcnt(7)
    s_add_u32 m0, s60, 0
    s_mov_b32 s61, 98304
    buffer_load_dwordx4 v18, s[24:27], s61 offen nt lds
    ds_read_b128 v[32:35], v22 offset:6144
    ds_read_b64_tr_b16 v[48:49], v20 offset:8704
    ds_read_b64_tr_b16 v[50:51], v20 offset:12800
    ds_read_b64_tr_b16 v[52:53], v21 offset:8704
    ds_read_b64_tr_b16 v[54:55], v21 offset:12800
    s_waitcnt lgkmcnt(5)
    v_mfma_f32_32x32x16_bf16 v[176:191], v[56:59], v[36:39], v[176:191]
    v_mfma_f32_32x32x16_bf16 v[192:207], v[60:63], v[36:39], v[192:207]
    s_waitcnt vmcnt(7)
    s_add_u32 m0, s60, 1024
    s_mov_b32 s61, 102400
    buffer_load_dwordx4 v19, s[24:27], s61 offen nt lds
    ds_read_b128 v[36:39], v22 offset:7168
    ds_read_b64_tr_b16 v[56:57], v20 offset:8960
    ds_read_b64_tr_b16 v[58:59], v20 offset:13056
    ds_read_b64_tr_b16 v[60:61], v21 offset:8960
    ds_read_b64_tr_b16 v[62:63], v21 offset:13056
    s_waitcnt lgkmcnt(5)
    v_mfma_f32_32x32x16_bf16 v[176:191], v[48:51], v[32:35], v[176:191]
    v_mfma_f32_32x32x16_bf16 v[192:207], v[52:55], v[32:35], v[192:207]
    s_waitcnt vmcnt(7)
    s_add_u32 m0, s60, 2048
    s_mov_b32 s61, 106496
    buffer_load_dwordx4 v18, s[24:27], s61 offen nt lds
    s_waitcnt lgkmcnt(0)
    v_mfma_f32_32x32x16_bf16 v[176:191], v[56:59], v[36:39], v[176:191]
    v_mfma_f32_32x32x16_bf16 v[192:207], v[60:63], v[36:39], v[192:207]
    s_waitcnt vmcnt(7)
    s_add_u32 m0, s60, 3072
    s_mov_b32 s61, 110592
    buffer_load_dwordx4 v19, s[24:27], s61 offen nt lds
    s_waitcnt vmcnt(7)
    s_add_u32 m0, s60, 4096
    s_mov_b32 s61, 114688
    buffer_load_dwordx4 v18, s[24:27], s61 offen nt lds
    s_waitcnt vmcnt(7)
    s_add_u32 m0, s60, 5120
    s_mov_b32 s61, 118784
    buffer_load_dwordx4 v19, s[24:27], s61 offen nt lds
    s_waitcnt vmcnt(7)
    s_add_u32 m0, s60, 6144
    s_mov_b32 s61, 122880
    buffer_load_dwordx4 v18, s[24:27], s61 offen nt lds
    s_waitcnt vmcnt(7)
    ds_read_b128 v[32:35], v22 offset:8192
    ds_read_b64_tr_b16 v[48:49], v20 offset:16384
    ds_read_b64_tr_b16 v[50:51], v20 offset:20480
    ds_read_b64_tr_b16 v[52:53], v21 offset:16384
    ds_read_b64_tr_b16 v[54:55], v21 offset:20480
    ds_read_b128 v[36:39], v22 offset:9216
    ds_read_b64_tr_b16 v[56:57], v20 offset:16640
    ds_read_b64_tr_b16 v[58:59], v20 offset:20736
    ds_read_b64_tr_b16 v[60:61], v21 offset:16640
    ds_read_b64_tr_b16 v[62:63], v21 offset:20736
    s_waitcnt lgkmcnt(5)
    v_mfma_f32_32x32x16_bf16 v[176:191], v[48:51], v[32:35], v[176:191]
    v_mfma_f32_32x32x16_bf16 v[192:207], v[52:55], v[32:35], v[192:207]
    s_waitcnt vmcnt(7)
    s_add_u32 m0, s60, 7168
    s_mov_b32 s61, 126976
    buffer_load_dwordx4 v19, s[24:27], s61 offen nt lds
    ds_read_b128 v[32:35], v22 offset:10240
    ds_read_b64_tr_b16 v[48:49], v20 offset:16896
    ds_read_b64_tr_b16 v[50:51], v20 offset:20992
    ds_read_b64_tr_b16 v[52:53], v21 offset:16896
    ds_read_b64_tr_b16 v[54:55], v21 offset:20992
    s_waitcnt lgkmcnt(5)
    v_mfma_f32_32x32x16_bf16 v[176:191], v[56:59], v[36:39], v[176:191]
    v_mfma_f32_32x32x16_bf16 v[192:207], v[60:63], v[36:39], v[192:207]
    s_waitcnt vmcnt(7)
    s_add_u32 m0, s60, 8192
    s_mov_b32 s61, 131072
    buffer_load_dwordx4 v18, s[24:27], s61 offen nt lds
    ds_read_b128 v[36:39], v22 offset:11264
    ds_read_b64_tr_b16 v[56:57], v20 offset:17152
    ds_read_b64_tr_b16 v[58:59], v20 offset:21248
    ds_read_b64_tr_b16 v[60:61], v21 offset:17152
    ds_read_b64_tr_b16 v[62:63], v21 offset:21248
    s_waitcnt lgkmcnt(5)
    v_mfma_f32_32x32x16_bf16 v[176:191], v[48:51], v[32:35], v[176:191]
    v_mfma_f32_32x32x16_bf16 v[192:207], v[52:55], v[32:35], v[192:207]
    s_waitcnt vmcnt(7)
    s_add_u32 m0, s60, 9216
    s_mov_b32 s61, 135168
    buffer_load_dwordx4 v19, s[24:27], s61 offen nt lds
    s_waitcnt lgkmcnt(0)
    v_mfma_f32_32x32x16_bf16 v[176:191], v[56:59], v[36:39], v[176:191]
    v_mfma_f32_32x32x16_bf16 v[192:207], v[60:63], v[36:39], v[192:207]
    s_waitcnt vmcnt(7)
    s_add_u32 m0, s60, 10240
    s_mov_b32 s61, 139264
    buffer_load_dwordx4 v18, s[24:27], s61 offen nt lds
    s_waitcnt vmcnt(7)
    s_add_u32 m0, s60, 11264
    s_mov_b32 s61, 143360
    buffer_load_dwordx4 v19, s[24:27], s61 offen nt lds
    s_waitcnt vmcnt(7)
    s_add_u32 m0, s60, 12288
    s_mov_b32 s61, 147456
    buffer_load_dwordx4 v18, s[24:27], s61 offen nt lds
    s_waitcnt vmcnt(7)
    s_add_u32 m0, s60, 13312
    s_mov_b32 s61, 151552
    buffer_load_dwordx4 v19, s[24:27], s61 offen nt lds
    s_waitcnt vmcnt(7)
    s_add_u32 m0, s60, 14336
    s_mov_b32 s61, 155648
    buffer_load_dwordx4 v18, s[24:27], s61 offen nt lds
    s_waitcnt vmcnt(7)
    ds_read_b128 v[32:35], v22 offset:12288
    ds_read_b64_tr_b16 v[48:49], v20 offset:0
    ds_read_b64_tr_b16 v[50:51], v20 offset:4096
    ds_read_b64_tr_b16 v[52:53], v21 offset:0
    ds_read_b64_tr_b16 v[54:55], v21 offset:4096
    ds_read_b128 v[36:39], v22 offset:13312
    ds_read_b64_tr_b16 v[56:57], v20 offset:256
    ds_read_b64_tr_b16 v[58:59], v20 offset:4352
    ds_read_b64_tr_b16 v[60:61], v21 offset:256
    ds_read_b64_tr_b16 v[62:63], v21 offset:4352
    s_waitcnt lgkmcnt(5)
    v_mfma_f32_32x32x16_bf16 v[176:191], v[48:51], v[32:35], v[176:191]
    v_mfma_f32_32x32x16_bf16 v[192:207], v[52:55], v[32:35], v[192:207]
    s_waitcnt vmcnt(7)
    s_add_u32 m0, s60, 15360
    s_mov_b32 s61, 159744
    buffer_load_dwordx4 v19, s[24:27], s61 offen nt lds
    ds_read_b128 v[32:35], v22 offset:14336
    ds_read_b64_tr_b16 v[48:49], v20 offset:512
    ds_read_b64_tr_b16 v[50:51], v20 offset:4608
    ds_read_b64_tr_b16 v[52:53], v21 offset:512
    ds_read_b64_tr_b16 v[54:55], v21 offset:4608
    s_waitcnt lgkmcnt(5)
    v_mfma_f32_32x32x16_bf16 v[176:191], v[56:59], v[36:39], v[176:191]
    v_mfma_f32_32x32x16_bf16 v[192:207], v[60:63], v[36:39], v[192:207]
    s_waitcnt vmcnt(7)
    s_add_u32 m0, s60, 16384
    s_mov_b32 s61, 163840
    buffer_load_dwordx4 v18, s[24:27], s61 offen nt lds
    ds_read_b128 v[36:39], v22 offset:15360
    ds_read_b64_tr_b16 v[56:57], v20 offset:768
    ds_read_b64_tr_b16 v[58:59], v20 offset:4864
    ds_read_b64_tr_b16 v[60:61], v21 offset:768
    ds_read_b64_tr_b16 v[62:63], v21 offset:4864
    s_waitcnt lgkmcnt(5)
    v_mfma_f32_32x32x16_bf16 v[176:191], v[48:51], v[32:35], v[176:191]
    v_mfma_f32_32x32x16_bf16 v[192:207], v[52:55], v[32:35], v[192:207]
    s_waitcnt vmcnt(7)
    s_add_u32 m0, s60, 17408
    s_mov_b32 s61, 167936
    buffer_load_dwordx4 v19, s[24:27], s61 offen nt lds
    s_waitcnt lgkmcnt(0)
    v_mfma_f32_32x32x16_bf16 v[176:191], v[56:59], v[36:39], v[176:191]
    v_mfma_f32_32x32x16_bf16 v[192:207], v[60:63], v[36:39], v[192:207]
    s_waitcnt vmcnt(7)
    s_add_u32 m0, s60, 18432
    s_mov_b32 s61, 172032
    buffer_load_dwordx4 v18, s[24:27], s61 offen nt lds
    s_waitcnt vmcnt(7)
    s_add_u32 m0, s60, 19456
    s_mov_b32 s61, 176128
    buffer_load_dwordx4 v19, s[24:27], s61 offen nt lds
    s_waitcnt vmcnt(7)
    s_add_u32 m0, s60, 20480
    s_mov_b32 s61, 180224
    buffer_load_dwordx4 v18, s[24:27], s61 offen nt lds
    s_waitcnt vmcnt(7)
    s_add_u32 m0, s60, 21504
    s_mov_b32 s61, 184320
    buffer_load_dwordx4 v19, s[24:27], s61 offen nt lds
    s_waitcnt vmcnt(7)
    s_add_u32 m0, s60, 22528
    s_mov_b32 s61, 188416
    buffer_load_dwordx4 v18, s[24:27], s61 offen nt lds
    s_waitcnt vmcnt(7)
    ds_read_b128 v[32:35], v22 offset:16384
    ds_read_b64_tr_b16 v[48:49], v20 offset:8192
    ds_read_b64_tr_b16 v[50:51], v20 offset:12288
    ds_read_b64_tr_b16 v[52:53], v21 offset:8192
    ds_read_b64_tr_b16 v[54:55], v21 offset:12288
    ds_read_b128 v[36:39], v22 offset:17408
    ds_read_b64_tr_b16 v[56:57], v20 offset:8448
    ds_read_b64_tr_b16 v[58:59], v20 offset:12544
    ds_read_b64_tr_b16 v[60:61], v21 offset:8448
    ds_read_b64_tr_b16 v[62:63], v21 offset:12544
    s_waitcnt lgkmcnt(5)
    v_mfma_f32_32x32x16_bf16 v[176:191], v[48:51], v[32:35], v[176:191]
    v_mfma_f32_32x32x16_bf16 v[192:207], v[52:55], v[32:35], v[192:207]
    s_waitcnt vmcnt(7)
    s_add_u32 m0, s60, 23552
    s_mov_b32 s61, 192512
    buffer_load_dwordx4 v19, s[24:27], s61 offen nt lds
    ds_read_b128 v[32:35], v22 offset:18432
    ds_read_b64_tr_b16 v[48:49], v20 offset:8704
    ds_read_b64_tr_b16 v[50:51], v20 offset:12800
    ds_read_b64_tr_b16 v[52:53], v21 offset:8704
    ds_read_b64_tr_b16 v[54:55], v21 offset:12800
    s_waitcnt lgkmcnt(5)
    v_mfma_f32_32x32x16_bf16 v[176:191], v[56:59], v[36:39], v[176:191]
    v_mfma_f32_32x32x16_bf16 v[192:207], v[60:63], v[36:39], v[192:207]
    s_waitcnt vmcnt(7)
    s_add_u32 m0, s60, 0
    s_mov_b32 s61, 196608
    buffer_load_dwordx4 v18, s[24:27], s61 offen nt lds
    ds_read_b128 v[36:39], v22 offset:19456
    ds_read_b64_tr_b16 v[56:57], v20 offset:8960
    ds_read_b64_tr_b16 v[58:59], v20 offset:13056
    ds_read_b64_tr_b16 v[60:61], v21 offset:8960
    ds_read_b64_tr_b16 v[62:63], v21 offset:13056
    s_waitcnt lgkmcnt(5)
    v_mfma_f32_32x32x16_bf16 v[176:191], v[48:51], v[32:35], v[176:191]
    v_mfma_f32_32x32x16_bf16 v[192:207], v[52:55], v[32:35], v[192:207]
    s_waitcnt vmcnt(7)
    s_add_u32 m0, s60, 1024
    s_mov_b32 s61, 200704
    buffer_load_dwordx4 v19, s[24:27], s61 offen nt lds
    s_waitcnt lgkmcnt(0)
    v_mfma_f32_32x32x16_bf16 v[176:191], v[56:59], v[36:39], v[176:191]
    v_mfma_f32_32x32x16_bf16 v[192:207], v[60:63], v[36:39], v[192:207]
    s_waitcnt vmcnt(7)
    s_add_u32 m0, s60, 2048
    s_mov_b32 s61, 204800
    buffer_load_dwordx4 v18, s[24:27], s61 offen nt lds
    s_waitcnt vmcnt(7)
    s_add_u32 m0, s60, 3072
    s_mov_b32 s61, 208896
    buffer_load_dwordx4 v19, s[24:27], s61 offen nt lds
    s_waitcnt vmcnt(7)
    s_add_u32 m0, s60, 4096
    s_mov_b32 s61, 212992
    buffer_load_dwordx4 v18, s[24:27], s61 offen nt lds
    s_waitcnt vmcnt(7)
    s_add_u32 m0, s60, 5120
    s_mov_b32 s61, 217088
    buffer_load_dwordx4 v19, s[24:27], s61 offen nt lds
    s_waitcnt vmcnt(7)
    s_add_u32 m0, s60, 6144
    s_mov_b32 s61, 221184
    buffer_load_dwordx4 v18, s[24:27], s61 offen nt lds
    s_waitcnt vmcnt(7)
    ds_read_b128 v[32:35], v22 offset:20480
    ds_read_b64_tr_b16 v[48:49], v20 offset:16384
    ds_read_b64_tr_b16 v[50:51], v20 offset:20480
    ds_read_b64_tr_b16 v[52:53], v21 offset:16384
    ds_read_b64_tr_b16 v[54:55], v21 offset:20480
    ds_read_b128 v[36:39], v22 offset:21504
    ds_read_b64_tr_b16 v[56:57], v20 offset:16640
    ds_read_b64_tr_b16 v[58:59], v20 offset:20736
    ds_read_b64_tr_b16 v[60:61], v21 offset:16640
    ds_read_b64_tr_b16 v[62:63], v21 offset:20736
    s_waitcnt lgkmcnt(5)
    v_mfma_f32_32x32x16_bf16 v[176:191], v[48:51], v[32:35], v[176:191]
    v_mfma_f32_32x32x16_bf16 v[192:207], v[52:55], v[32:35], v[192:207]
    s_waitcnt vmcnt(7)
    s_add_u32 m0, s60, 7168
    s_mov_b32 s61, 225280
    buffer_load_dwordx4 v19, s[24:27], s61 offen nt lds
    ds_read_b128 v[32:35], v22 offset:22528
    ds_read_b64_tr_b16 v[48:49], v20 offset:16896
    ds_read_b64_tr_b16 v[50:51], v20 offset:20992
    ds_read_b64_tr_b16 v[52:53], v21 offset:16896
    ds_read_b64_tr_b16 v[54:55], v21 offset:20992
    s_waitcnt lgkmcnt(5)
    v_mfma_f32_32x32x16_bf16 v[176:191], v[56:59], v[36:39], v[176:191]
    v_mfma_f32_32x32x16_bf16 v[192:207], v[60:63], v[36:39], v[192:207]
    s_waitcnt vmcnt(7)
    s_add_u32 m0, s60, 8192
    s_mov_b32 s61, 229376
    buffer_load_dwordx4 v18, s[24:27], s61 offen nt lds
    ds_read_b128 v[36:39], v22 offset:23552
    ds_read_b64_tr_b16 v[56:57], v20 offset:17152
    ds_read_b64_tr_b16 v[58:59], v20 offset:21248
    ds_read_b64_tr_b16 v[60:61], v21 offset:17152
    ds_read_b64_tr_b16 v[62:63], v21 offset:21248
    s_waitcnt lgkmcnt(5)
    v_mfma_f32_32x32x16_bf16 v[176:191], v[48:51], v[32:35], v[176:191]
    v_mfma_f32_32x32x16_bf16 v[192:207], v[52:55], v[32:35], v[192:207]
    s_waitcnt vmcnt(7)
    s_add_u32 m0, s60, 9216
    s_mov_b32 s61, 233472
    buffer_load_dwordx4 v19, s[24:27], s61 offen nt lds
    s_waitcnt lgkmcnt(0)
    v_mfma_f32_32x32x16_bf16 v[176:191], v[56:59], v[36:39], v[176:191]
    v_mfma_f32_32x32x16_bf16 v[192:207], v[60:63], v[36:39], v[192:207]
    s_waitcnt vmcnt(7)
    s_add_u32 m0, s60, 10240
    s_mov_b32 s61, 237568
    buffer_load_dwordx4 v18, s[24:27], s61 offen nt lds
    s_waitcnt vmcnt(7)
    s_add_u32 m0, s60, 11264
    s_mov_b32 s61, 241664
    buffer_load_dwordx4 v19, s[24:27], s61 offen nt lds
    s_waitcnt vmcnt(7)
    s_add_u32 m0, s60, 12288
    s_mov_b32 s61, 245760
    buffer_load_dwordx4 v18, s[24:27], s61 offen nt lds
    s_waitcnt vmcnt(7)
    s_add_u32 m0, s60, 13312
    s_mov_b32 s61, 249856
    buffer_load_dwordx4 v19, s[24:27], s61 offen nt lds
    s_waitcnt vmcnt(7)
    s_add_u32 m0, s60, 14336
    s_mov_b32 s61, 253952
    buffer_load_dwordx4 v18, s[24:27], s61 offen nt lds
    s_waitcnt vmcnt(7)
    ds_read_b128 v[32:35], v22 offset:24576
    ds_read_b64_tr_b16 v[48:49], v20 offset:0
    ds_read_b64_tr_b16 v[50:51], v20 offset:4096
    ds_read_b64_tr_b16 v[52:53], v21 offset:0
    ds_read_b64_tr_b16 v[54:55], v21 offset:4096
    ds_read_b128 v[36:39], v22 offset:25600
    ds_read_b64_tr_b16 v[56:57], v20 offset:256
    ds_read_b64_tr_b16 v[58:59], v20 offset:4352
    ds_read_b64_tr_b16 v[60:61], v21 offset:256
    ds_read_b64_tr_b16 v[62:63], v21 offset:4352
    s_waitcnt lgkmcnt(5)
    v_mfma_f32_32x32x16_bf16 v[176:191], v[48:51], v[32:35], v[176:191]
    v_mfma_f32_32x32x16_bf16 v[192:207], v[52:55], v[32:35], v[192:207]
    s_waitcnt vmcnt(7)
    s_add_u32 m0, s60, 15360
    s_mov_b32 s61, 258048
    buffer_load_dwordx4 v19, s[24:27], s61 offen nt lds
    ds_read_b128 v[32:35], v22 offset:26624
    ds_read_b64_tr_b16 v[48:49], v20 offset:512
    ds_read_b64_tr_b16 v[50:51], v20 offset:4608
    ds_read_b64_tr_b16 v[52:53], v21 offset:512
    ds_read_b64_tr_b16 v[54:55], v21 offset:4608
    s_waitcnt lgkmcnt(5)
    v_mfma_f32_32x32x16_bf16 v[176:191], v[56:59], v[36:39], v[176:191]
    v_mfma_f32_32x32x16_bf16 v[192:207], v[60:63], v[36:39], v[192:207]
    ds_read_b128 v[36:39], v22 offset:27648
    ds_read_b64_tr_b16 v[56:57], v20 offset:768
    ds_read_b64_tr_b16 v[58:59], v20 offset:4864
    ds_read_b64_tr_b16 v[60:61], v21 offset:768
    ds_read_b64_tr_b16 v[62:63], v21 offset:4864
    s_waitcnt lgkmcnt(5)
    v_mfma_f32_32x32x16_bf16 v[176:191], v[48:51], v[32:35], v[176:191]
    v_mfma_f32_32x32x16_bf16 v[192:207], v[52:55], v[32:35], v[192:207]
    s_waitcnt lgkmcnt(0)
    v_mfma_f32_32x32x16_bf16 v[176:191], v[56:59], v[36:39], v[176:191]
    v_mfma_f32_32x32x16_bf16 v[192:207], v[60:63], v[36:39], v[192:207]
    s_waitcnt vmcnt(0)
    ds_read_b128 v[32:35], v22 offset:28672
    ds_read_b64_tr_b16 v[48:49], v20 offset:8192
    ds_read_b64_tr_b16 v[50:51], v20 offset:12288
    ds_read_b64_tr_b16 v[52:53], v21 offset:8192
    ds_read_b64_tr_b16 v[54:55], v21 offset:12288
    ds_read_b128 v[36:39], v22 offset:29696
    ds_read_b64_tr_b16 v[56:57], v20 offset:8448
    ds_read_b64_tr_b16 v[58:59], v20 offset:12544
    ds_read_b64_tr_b16 v[60:61], v21 offset:8448
    ds_read_b64_tr_b16 v[62:63], v21 offset:12544
    s_waitcnt lgkmcnt(5)
    v_mfma_f32_32x32x16_bf16 v[176:191], v[48:51], v[32:35], v[176:191]
    v_mfma_f32_32x32x16_bf16 v[192:207], v[52:55], v[32:35], v[192:207]
    ds_read_b128 v[32:35], v22 offset:30720
    ds_read_b64_tr_b16 v[48:49], v20 offset:8704
    ds_read_b64_tr_b16 v[50:51], v20 offset:12800
    ds_read_b64_tr_b16 v[52:53], v21 offset:8704
    ds_read_b64_tr_b16 v[54:55], v21 offset:12800
    s_waitcnt lgkmcnt(5)
    v_mfma_f32_32x32x16_bf16 v[176:191], v[56:59], v[36:39], v[176:191]
    v_mfma_f32_32x32x16_bf16 v[192:207], v[60:63], v[36:39], v[192:207]
    ds_read_b128 v[36:39], v22 offset:31744
    ds_read_b64_tr_b16 v[56:57], v20 offset:8960
    ds_read_b64_tr_b16 v[58:59], v20 offset:13056
    ds_read_b64_tr_b16 v[60:61], v21 offset:8960
    ds_read_b64_tr_b16 v[62:63], v21 offset:13056
    s_waitcnt lgkmcnt(5)
    v_mfma_f32_32x32x16_bf16 v[176:191], v[48:51], v[32:35], v[176:191]
    v_mfma_f32_32x32x16_bf16 v[192:207], v[52:55], v[32:35], v[192:207]
    s_waitcnt lgkmcnt(0)
    v_mfma_f32_32x32x16_bf16 v[176:191], v[56:59], v[36:39], v[176:191]
    v_mfma_f32_32x32x16_bf16 v[192:207], v[60:63], v[36:39], v[192:207]
    v_readfirstlane_b32 s53, v255
    s_lshl_b32 s54, s52, 8
    s_lshl_b32 s55, s48, 6
    s_add_u32 s54, s54, s55
    s_lshl_b32 s55, s50, 4
    s_add_u32 s54, s54, s55
    s_add_u32 s53, s53, 1
    s_and_b32 s53, s53, 0xfff
    s_add_u32 s54, s54, 3670016
    v_mov_b32 v24, 0
    v_mov_b32 v25, s53
    v_and_b32 v26, 31, v0
    v_lshlrev_b32 v26, 2, v26
    s_barrier
    ds_read_b32 v30, v26 offset:24832
    ds_read_b32 v31, v26 offset:24960
    s_lshl_b32 s54, s52, 17
    s_lshl_b32 s55, s48, 15
    s_add_u32 s54, s54, s55
    s_lshl_b32 s55, s50, 13
    s_add_u32 s54, s54, s55
    s_add_u32 s54, s54, 4194304
    v_lshlrev_b32 v27, 4, v0
    v_mov_b32 v28, s53
    s_waitcnt lgkmcnt(0)
    v_mul_f32 v176, v176, v30
    v_mul_f32 v177, v177, v30
    v_mul_f32 v178, v178, v30
    v_mul_f32 v179, v179, v30
    v_mul_f32 v180, v180, v30
    v_mul_f32 v181, v181, v30
    v_mul_f32 v182, v182, v30
    v_mul_f32 v183, v183, v30
    v_mul_f32 v184, v184, v30
    v_mul_f32 v185, v185, v30
    v_mul_f32 v186, v186, v30
    v_mul_f32 v187, v187, v30
    v_mul_f32 v188, v188, v30
    v_mul_f32 v189, v189, v30
    v_mul_f32 v190, v190, v30
    v_mul_f32 v191, v191, v30
    v_mul_f32 v192, v192, v30
    v_mul_f32 v193, v193, v30
    v_mul_f32 v194, v194, v30
    v_mul_f32 v195, v195, v30
    v_mul_f32 v196, v196, v30
    v_mul_f32 v197, v197, v30
    v_mul_f32 v198, v198, v30
    v_mul_f32 v199, v199, v30
    v_mul_f32 v200, v200, v30
    v_mul_f32 v201, v201, v30
    v_mul_f32 v202, v202, v30
    v_mul_f32 v203, v203, v30
    v_mul_f32 v204, v204, v30
    v_mul_f32 v205, v205, v30
    v_mul_f32 v206, v206, v30
    v_mul_f32 v207, v207, v30
    s_cmp_eq_u32 s48, s50
    s_cbranch_scc1 OWNW
    v_add_u32 v176, 0x800, v176
    v_and_or_b32 v176, v176, s80, v28
    v_add_u32 v177, 0x800, v177
    v_and_or_b32 v177, v177, s80, v28
    v_add_u32 v178, 0x800, v178
    v_and_or_b32 v178, v178, s80, v28
    v_add_u32 v179, 0x800, v179
    v_and_or_b32 v179, v179, s80, v28
    v_add_u32 v180, 0x800, v180
    v_and_or_b32 v180, v180, s80, v28
    v_add_u32 v181, 0x800, v181
    v_and_or_b32 v181, v181, s80, v28
    v_add_u32 v182, 0x800, v182
    v_and_or_b32 v182, v182, s80, v28
    v_add_u32 v183, 0x800, v183
    v_and_or_b32 v183, v183, s80, v28
    v_add_u32 v184, 0x800, v184
    v_and_or_b32 v184, v184, s80, v28
    v_add_u32 v185, 0x800, v185
    v_and_or_b32 v185, v185, s80, v28
    v_add_u32 v186, 0x800, v186
    v_and_or_b32 v186, v186, s80, v28
    v_add_u32 v187, 0x800, v187
    v_and_or_b32 v187, v187, s80, v28
    v_add_u32 v188, 0x800, v188
    v_and_or_b32 v188, v188, s80, v28
    v_add_u32 v189, 0x800, v189
    v_and_or_b32 v189, v189, s80, v28
    v_add_u32 v190, 0x800, v190
    v_and_or_b32 v190, v190, s80, v28
    v_add_u32 v191, 0x800, v191
    v_and_or_b32 v191, v191, s80, v28
    v_add_u32 v192, 0x800, v192
    v_and_or_b32 v192, v192, s80, v28
    v_add_u32 v193, 0x800, v193
    v_and_or_b32 v193, v193, s80, v28
    v_add_u32 v194, 0x800, v194
    v_and_or_b32 v194, v194, s80, v28
    v_add_u32 v195, 0x800, v195
    v_and_or_b32 v195, v195, s80, v28
    v_add_u32 v196, 0x800, v196
    v_and_or_b32 v196, v196, s80, v28
    v_add_u32 v197, 0x800, v197
    v_and_or_b32 v197, v197, s80, v28
    v_add_u32 v198, 0x800, v198
    v_and_or_b32 v198, v198, s80, v28
    v_add_u32 v199, 0x800, v199
    v_and_or_b32 v199, v199, s80, v28
    v_add_u32 v200, 0x800, v200
    v_and_or_b32 v200, v200, s80, v28
    v_add_u32 v201, 0x800, v201
    v_and_or_b32 v201, v201, s80, v28
    v_add_u32 v202, 0x800, v202
    v_and_or_b32 v202, v202, s80, v28
    v_add_u32 v203, 0x800, v203
    v_and_or_b32 v203, v203, s80, v28
    v_add_u32 v204, 0x800, v204
    v_and_or_b32 v204, v204, s80, v28
    v_add_u32 v205, 0x800, v205
    v_and_or_b32 v205, v205, s80, v28
    v_add_u32 v206, 0x800, v206
    v_and_or_b32 v206, v206, s80, v28
    v_add_u32 v207, 0x800, v207
    v_and_or_b32 v207, v207, s80, v28
    v_add_u32 v29, 4096, v27
    v_readfirstlane_b32 s92, v31
    s_nop 3
    s_cmp_eq_u32 s92, 0
    s_cbranch_scc1 H1SC
    buffer_store_dwordx4 v[176:179], v27, s[28:31], s54 offen offset:0
    buffer_store_dwordx4 v[180:183], v27, s[28:31], s54 offen offset:1024
    buffer_store_dwordx4 v[184:187], v27, s[28:31], s54 offen offset:2048
    buffer_store_dwordx4 v[188:191], v27, s[28:31], s54 offen offset:3072
    buffer_store_dwordx4 v[192:195], v29, s[28:31], s54 offen offset:0
    buffer_store_dwordx4 v[196:199], v29, s[28:31], s54 offen offset:1024
    buffer_store_dwordx4 v[200:203], v29, s[28:31], s54 offen offset:2048
    buffer_store_dwordx4 v[204:207], v29, s[28:31], s54 offen offset:3072
    s_branch OWND
H1SC:
    buffer_store_dwordx4 v[176:179], v27, s[28:31], s54 offen offset:0 sc1
    buffer_store_dwordx4 v[180:183], v27, s[28:31], s54 offen offset:1024 sc1
    buffer_store_dwordx4 v[184:187], v27, s[28:31], s54 offen offset:2048 sc1
    buffer_store_dwordx4 v[188:191], v27, s[28:31], s54 offen offset:3072 sc1
    buffer_store_dwordx4 v[192:195], v29, s[28:31], s54 offen offset:0 sc1
    buffer_store_dwordx4 v[196:199], v29, s[28:31], s54 offen offset:1024 sc1
    buffer_store_dwordx4 v[200:203], v29, s[28:31], s54 offen offset:2048 sc1
    buffer_store_dwordx4 v[204:207], v29, s[28:31], s54 offen offset:3072 sc1
    s_branch OWND
OWNW:
    v_add_u32 v27, 131072, v27
    ds_write_b128 v27, v[176:179] offset:0
    ds_write_b128 v27, v[180:183] offset:1024
    ds_write_b128 v27, v[184:187] offset:2048
    ds_write_b128 v27, v[188:191] offset:3072
    ds_write_b128 v27, v[192:195] offset:4096
    ds_write_b128 v27, v[196:199] offset:5120
    ds_write_b128 v27, v[200:203] offset:6144
    ds_write_b128 v27, v[204:207] offset:7168
    s_waitcnt lgkmcnt(0)
OWND:
    s_barrier
    s_barrier
    s_and_b32 s58, s2, 31
    s_lshr_b32 s59, s58, 1
    s_and_b32 s58, s58, 1
    s_mul_i32 s54, s59, 1792
    s_lshl_b32 s55, s58, 7
    s_add_u32 s54, s54, s55
    s_lshl_b32 s55, s51, 5
    s_lshl_b32 s56, s48, 3
    s_add_u32 s55, s55, s56
    s_mul_i32 s55, s55, 28672
    s_add_u32 s54, s54, s55
    s_add_u32 s54, s54, 16777216
    s_add_u32 s55, s54, 57344
    s_add_u32 s56, s55, 57344
    s_add_u32 s57, s56, 57344
    v_lshrrev_b32 v4, 3, v0
    v_and_b32 v5, 7, v0
    v_lshlrev_b32 v6, 4, v5
    v_lshl_add_u32 v6, v4, 8, v6
    v_add_u32 v7, 28672, v6
    v_lshlrev_b32 v2, 4, v0
    s_lshl_b32 s61, s48, 10
    s_add_u32 s61, s61, 143360
    v_add_u32 v3, s61, v2
    v_lshlrev_b32 v16, 4, v0
    s_lshl_b32 s61, s51, 11
    v_add_u32 v16, s61, v16
    s_lshl_b32 s61, s48, 9
    s_add_u32 s61, s61, 3735552
    v_mul_u32_u24 v16, 28672, v0
    v_add_u32 v16, 1648, v16
    s_mov_b64 exec, 0xff
    s_mov_b32 s62, 40000
    s_setprio 0
H2PL:
    buffer_load_dword v14, v16, s[28:31], s54 offen sc1
    s_waitcnt vmcnt(0)
    v_xor_b32 v14, s53, v14
    v_and_b32 v14, 0xfff, v14
    v_cmp_ne_u32 vcc, 0, v14
    s_nop 4
    s_bcnt1_i32_b32 s95, vcc_lo
    s_cmp_le_u32 s95, 0
    s_cbranch_scc1 H2PD
    s_sub_u32 s62, s62, 1
    s_cmp_lg_u32 s62, 0
    s_cbranch_scc1 H2PL
H2PD:
    s_mov_b32 exec_lo, -1
    s_mov_b32 exec_hi, 0xffffff
    s_mov_b32 s95, 0xff
    s_mov_b32 s62, 40000
H2GL:
    s_bitcmp1_b32 s95, 0
    s_cbranch_scc0 H2L0
    buffer_load_dwordx4 v[208:211], v6, s[28:31], s54 offen sc1
H2L0:
    s_bitcmp1_b32 s95, 1
    s_cbranch_scc0 H2L1
    buffer_load_dwordx4 v[212:215], v7, s[28:31], s54 offen sc1
H2L1:
    s_bitcmp1_b32 s95, 2
    s_cbranch_scc0 H2L2
    buffer_load_dwordx4 v[216:219], v6, s[28:31], s55 offen sc1
H2L2:
    s_bitcmp1_b32 s95, 3
    s_cbranch_scc0 H2L3
    buffer_load_dwordx4 v[220:223], v7, s[28:31], s55 offen sc1
H2L3:
    s_bitcmp1_b32 s95, 4
    s_cbranch_scc0 H2L4
    buffer_load_dwordx4 v[224:227], v6, s[28:31], s56 offen sc1
H2L4:
    s_bitcmp1_b32 s95, 5
    s_cbranch_scc0 H2L5
    buffer_load_dwordx4 v[228:231], v7, s[28:31], s56 offen sc1
H2L5:
    s_bitcmp1_b32 s95, 6
    s_cbranch_scc0 H2L6
    buffer_load_dwordx4 v[232:235], v6, s[28:31], s57 offen sc1
H2L6:
    s_bitcmp1_b32 s95, 7
    s_cbranch_scc0 H2L7
    buffer_load_dwordx4 v[236:239], v7, s[28:31], s57 offen sc1
H2L7:
    s_waitcnt vmcnt(0)
    s_bitcmp1_b32 s95, 0
    s_cbranch_scc0 H2C0
    v_xor_b32 v14, s53, v208
    v_xor_b32 v15, s53, v209
    v_or_b32 v14, v14, v15
    v_xor_b32 v15, s53, v210
    v_or_b32 v14, v14, v15
    v_xor_b32 v15, s53, v211
    v_or_b32 v14, v14, v15
    v_and_b32 v14, 0xfff, v14
    v_cmp_ne_u32 vcc, 0, v14
    s_nop 4
    s_cmp_eq_u64 vcc, 0
    s_cbranch_scc0 H2C0
    s_bitset0_b32 s95, 0
H2C0:
    s_bitcmp1_b32 s95, 1
    s_cbranch_scc0 H2C1
    v_xor_b32 v14, s53, v212
    v_xor_b32 v15, s53, v213
    v_or_b32 v14, v14, v15
    v_xor_b32 v15, s53, v214
    v_or_b32 v14, v14, v15
    v_xor_b32 v15, s53, v215
    v_or_b32 v14, v14, v15
    v_and_b32 v14, 0xfff, v14
    v_cmp_ne_u32 vcc, 0, v14
    s_nop 4
    s_cmp_eq_u64 vcc, 0
    s_cbranch_scc0 H2C1
    s_bitset0_b32 s95, 1
H2C1:
    s_bitcmp1_b32 s95, 2
    s_cbranch_scc0 H2C2
    v_xor_b32 v14, s53, v216
    v_xor_b32 v15, s53, v217
    v_or_b32 v14, v14, v15
    v_xor_b32 v15, s53, v218
    v_or_b32 v14, v14, v15
    v_xor_b32 v15, s53, v219
    v_or_b32 v14, v14, v15
    v_and_b32 v14, 0xfff, v14
    v_cmp_ne_u32 vcc, 0, v14
    s_nop 4
    s_cmp_eq_u64 vcc, 0
    s_cbranch_scc0 H2C2
    s_bitset0_b32 s95, 2
H2C2:
    s_bitcmp1_b32 s95, 3
    s_cbranch_scc0 H2C3
    v_xor_b32 v14, s53, v220
    v_xor_b32 v15, s53, v221
    v_or_b32 v14, v14, v15
    v_xor_b32 v15, s53, v222
    v_or_b32 v14, v14, v15
    v_xor_b32 v15, s53, v223
    v_or_b32 v14, v14, v15
    v_and_b32 v14, 0xfff, v14
    v_cmp_ne_u32 vcc, 0, v14
    s_nop 4
    s_cmp_eq_u64 vcc, 0
    s_cbranch_scc0 H2C3
    s_bitset0_b32 s95, 3
H2C3:
    s_bitcmp1_b32 s95, 4
    s_cbranch_scc0 H2C4
    v_xor_b32 v14, s53, v224
    v_xor_b32 v15, s53, v225
    v_or_b32 v14, v14, v15
    v_xor_b32 v15, s53, v226
    v_or_b32 v14, v14, v15
    v_xor_b32 v15, s53, v227
    v_or_b32 v14, v14, v15
    v_and_b32 v14, 0xfff, v14
    v_cmp_ne_u32 vcc, 0, v14
    s_nop 4
    s_cmp_eq_u64 vcc, 0
    s_cbranch_scc0 H2C4
    s_bitset0_b32 s95, 4
H2C4:
    s_bitcmp1_b32 s95, 5
    s_cbranch_scc0 H2C5
    v_xor_b32 v14, s53, v228
    v_xor_b32 v15, s53, v229
    v_or_b32 v14, v14, v15
    v_xor_b32 v15, s53, v230
    v_or_b32 v14, v14, v15
    v_xor_b32 v15, s53, v231
    v_or_b32 v14, v14, v15
    v_and_b32 v14, 0xfff, v14
    v_cmp_ne_u32 vcc, 0, v14
    s_nop 4
    s_cmp_eq_u64 vcc, 0
    s_cbranch_scc0 H2C5
    s_bitset0_b32 s95, 5
H2C5:
    s_bitcmp1_b32 s95, 6
    s_cbranch_scc0 H2C6
    v_xor_b32 v14, s53, v232
    v_xor_b32 v15, s53, v233
    v_or_b32 v14, v14, v15
    v_xor_b32 v15, s53, v234
    v_or_b32 v14, v14, v15
    v_xor_b32 v15, s53, v235
    v_or_b32 v14, v14, v15
    v_and_b32 v14, 0xfff, v14
    v_cmp_ne_u32 vcc, 0, v14
    s_nop 4
    s_cmp_eq_u64 vcc, 0
    s_cbranch_scc0 H2C6
    s_bitset0_b32 s95, 6
H2C6:
    s_bitcmp1_b32 s95, 7
    s_cbranch_scc0 H2C7
    v_xor_b32 v14, s53, v236
    v_xor_b32 v15, s53, v237
    v_or_b32 v14, v14, v15
    v_xor_b32 v15, s53, v238
    v_or_b32 v14, v14, v15
    v_xor_b32 v15, s53, v239
    v_or_b32 v14, v14, v15
    v_and_b32 v14, 0xfff, v14
    v_cmp_ne_u32 vcc, 0, v14
    s_nop 4
    s_cmp_eq_u64 vcc, 0
    s_cbranch_scc0 H2C7
    s_bitset0_b32 s95, 7
H2C7:
    s_cmp_eq_u32 s95, 0
    s_cbranch_scc1 H2GD
    s_sub_u32 s62, s62, 1
    s_cmp_lg_u32 s62, 0
    s_cbranch_scc1 H2GL
H2GD:
    v_and_b32 v208, s80, v208
    v_and_b32 v212, s80, v212
    v_and_b32 v216, s80, v216
    v_and_b32 v220, s80, v220
    v_and_b32 v224, s80, v224
    v_and_b32 v228, s80, v228
    v_and_b32 v232, s80, v232
    v_and_b32 v236, s80, v236
    v_add_f32 v208, v208, v212
    v_add_f32 v216, v216, v220
    v_add_f32 v224, v224, v228
    v_add_f32 v232, v232, v236
    v_add_f32 v208, v208, v216
    v_add_f32 v224, v224, v232
    v_add_f32 v208, v208, v224
    v_and_b32 v209, s80, v209
    v_and_b32 v213, s80, v213
    v_and_b32 v217, s80, v217
    v_and_b32 v221, s80, v221
    v_and_b32 v225, s80, v225
    v_and_b32 v229, s80, v229
    v_and_b32 v233, s80, v233
    v_and_b32 v237, s80, v237
    v_add_f32 v209, v209, v213
    v_add_f32 v217, v217, v221
    v_add_f32 v225, v225, v229
    v_add_f32 v233, v233, v237
    v_add_f32 v209, v209, v217
    v_add_f32 v225, v225, v233
    v_add_f32 v209, v209, v225
    v_and_b32 v210, s80, v210
    v_and_b32 v214, s80, v214
    v_and_b32 v218, s80, v218
    v_and_b32 v222, s80, v222
    v_and_b32 v226, s80, v226
    v_and_b32 v230, s80, v230
    v_and_b32 v234, s80, v234
    v_and_b32 v238, s80, v238
    v_add_f32 v210, v210, v214
    v_add_f32 v218, v218, v222
    v_add_f32 v226, v226, v230
    v_add_f32 v234, v234, v238
    v_add_f32 v210, v210, v218
    v_add_f32 v226, v226, v234
    v_add_f32 v210, v210, v226
    v_and_b32 v211, s80, v211
    v_and_b32 v215, s80, v215
    v_and_b32 v219, s80, v219
    v_and_b32 v223, s80, v223
    v_and_b32 v227, s80, v227
    v_and_b32 v231, s80, v231
    v_and_b32 v235, s80, v235
    v_and_b32 v239, s80, v239
    v_add_f32 v211, v211, v215
    v_add_f32 v219, v219, v223
    v_add_f32 v227, v227, v231
    v_add_f32 v235, v235, v239
    v_add_f32 v211, v211, v219
    v_add_f32 v227, v227, v235
    v_add_f32 v211, v211, v227
    ds_write_b128 v3, v[208:211]
    s_waitcnt lgkmcnt(0)
    s_barrier
    s_cmp_lg_u32 s48, 0
    s_cbranch_scc1 FIN
    v_add_u32 v3, 143360, v2
    ds_read_b128 v[160:163], v3 offset:0
    ds_read_b128 v[164:167], v3 offset:1024
    ds_read_b128 v[168:171], v3 offset:2048
    ds_read_b128 v[172:175], v3 offset:3072
    s_mov_b32 s44, s14
    s_mov_b32 s45, s15
    s_mov_b32 s46, 114688
    s_mov_b32 s47, 0x00020000
    s_lshl_b32 s54, s51, 4
    s_lshl_b32 s55, s58, 3
    s_add_u32 s54, s54, s55
    s_mul_i32 s54, s54, 896
    s_mul_i32 s55, s59, 56
    s_add_u32 s54, s54, s55
    v_mul_u32_u24 v5, 896, v5
    v_lshl_add_u32 v5, v4, 3, v5
    v_add_u32 v5, s54, v5
    s_waitcnt lgkmcnt(0)
    v_add_f32 v160, v160, v164
    v_add_f32 v168, v168, v172
    v_add_f32 v160, v160, v168
    v_add_f32 v161, v161, v165
    v_add_f32 v169, v169, v173
    v_add_f32 v161, v161, v169
    v_add_f32 v162, v162, v166
    v_add_f32 v170, v170, v174
    v_add_f32 v162, v162, v170
    v_add_f32 v163, v163, v167
    v_add_f32 v171, v171, v175
    v_add_f32 v163, v163, v171
    v_cvt_pk_bf16_f32 v160, v160, v161
    v_cvt_pk_bf16_f32 v161, v162, v163
    buffer_store_dwordx2 v[160:161], v5, s[44:47], 0 offen
    s_and_b32 s54, s2, 31
    s_cmp_lg_u32 s54, 0
    s_cbranch_scc1 FIN
    v_readfirstlane_b32 s54, v255
    s_lshl_b32 s55, s51, 7
    v_mov_b32 v7, s55
    s_add_u32 s54, s54, 1
    v_mov_b32 v8, s54
    s_mov_b64 exec, 1
    buffer_store_dword v8, v7, s[28:31], 0 offen sc1
FIN:
    s_endpgm
HELPER:
    s_sub_u32 s81, s48, 4
    s_mov_b32 s82, 0x05040100
    s_mov_b32 s83, 0x07060302
    v_mov_b32 v8, 0
    v_mov_b32 v9, 0
    v_mov_b32 v10, 0
    v_mov_b32 v11, 0
    s_lshl_b32 s54, s81, 13
    s_add_u32 s54, s54, 131072
    v_lshlrev_b32 v2, 4, v0
    v_add_u32 v2, s54, v2
    ds_write_b128 v2, v[8:11]
    ds_write_b128 v2, v[8:11] offset:1024
    ds_write_b128 v2, v[8:11] offset:2048
    ds_write_b128 v2, v[8:11] offset:3072
    ds_write_b128 v2, v[8:11] offset:4096
    ds_write_b128 v2, v[8:11] offset:5120
    ds_write_b128 v2, v[8:11] offset:6144
    ds_write_b128 v2, v[8:11] offset:7168
    s_mul_i32 s54, s51, 14336
    s_add_u32 s40, s4, s54
    s_addc_u32 s41, s5, 0
    s_mov_b32 s42, 14336
    s_mov_b32 s43, 0x00020000
    s_mov_b32 s32, s10
    s_mov_b32 s33, s11
    s_mov_b32 s34, 3670016
    s_mov_b32 s35, 0x00020000
    s_mov_b32 s36, s12
    s_mov_b32 s37, s13
    s_mov_b32 s38, 3670016
    s_mov_b32 s39, 0x00020000
    v_and_b32 v4, 15, v0
    v_lshrrev_b32 v5, 4, v0
    s_mul_i32 s54, s81, 14
    s_mul_i32 s55, s51, 7
    s_add_u32 s54, s54, s55
    v_mul_u32_u24 v6, 896, v4
    s_lshl_b32 s55, s49, 10
    s_lshl_b32 s56, s50, 8
    s_add_u32 s55, s55, s56
    v_lshlrev_b32 v7, 4, v4
    v_add_u32 v7, s55, v7
    v_add_u32 v160, s54, v5
    v_add_u32 v160, 0, v160
    v_subrev_u32 v161, 56, v160
    v_min_u32 v160, v160, v161
    v_lshl_add_u32 v164, v160, 4, v6
    buffer_load_dwordx4 v[16:19], v164, s[40:43], 0 offen
    v_lshl_add_u32 v12, v160, 16, v7
    v_add_u32 v160, s54, v5
    v_add_u32 v160, 4, v160
    v_subrev_u32 v161, 56, v160
    v_min_u32 v160, v160, v161
    v_lshl_add_u32 v165, v160, 4, v6
    buffer_load_dwordx4 v[20:23], v165, s[40:43], 0 offen
    v_lshl_add_u32 v13, v160, 16, v7
    v_add_u32 v160, s54, v5
    v_add_u32 v160, 8, v160
    v_subrev_u32 v161, 56, v160
    v_min_u32 v160, v160, v161
    v_lshl_add_u32 v166, v160, 4, v6
    buffer_load_dwordx4 v[24:27], v166, s[40:43], 0 offen
    v_lshl_add_u32 v14, v160, 16, v7
    v_add_u32 v160, s54, v5
    v_add_u32 v160, 12, v160
    v_subrev_u32 v161, 56, v160
    v_min_u32 v160, v160, v161
    v_lshl_add_u32 v167, v160, 4, v6
    buffer_load_dwordx4 v[28:31], v167, s[40:43], 0 offen
    v_and_b32 v160, 1, v5
    v_add_u32 v160, s54, v160
    v_add_u32 v160, 12, v160
    v_subrev_u32 v161, 56, v160
    v_min_u32 v160, v160, v161
    v_lshl_add_u32 v15, v160, 16, v7
    s_mov_b32 s61, 0
    buffer_load_dwordx4 v[32:35], v12, s[32:35], s61 offen nt
    s_mov_b32 s61, 8192
    buffer_load_dwordx4 v[36:39], v12, s[32:35], s61 offen nt
    s_mov_b32 s61, 16384
    buffer_load_dwordx4 v[40:43], v12, s[32:35], s61 offen nt
    s_mov_b32 s61, 24576
    buffer_load_dwordx4 v[44:47], v12, s[32:35], s61 offen nt
    s_mov_b32 s61, 32768
    buffer_load_dwordx4 v[48:51], v12, s[32:35], s61 offen nt
    s_mov_b32 s61, 40960
    buffer_load_dwordx4 v[52:55], v12, s[32:35], s61 offen nt
    s_mov_b32 s61, 49152
    buffer_load_dwordx4 v[56:59], v12, s[32:35], s61 offen nt
    s_mov_b32 s61, 57344
    buffer_load_dwordx4 v[60:63], v12, s[32:35], s61 offen nt
    s_mov_b32 s61, 0
    buffer_load_dwordx4 v[64:67], v13, s[32:35], s61 offen nt
    s_mov_b32 s61, 8192
    buffer_load_dwordx4 v[68:71], v13, s[32:35], s61 offen nt
    s_mov_b32 s61, 16384
    buffer_load_dwordx4 v[72:75], v13, s[32:35], s61 offen nt
    s_mov_b32 s61, 24576
    buffer_load_dwordx4 v[76:79], v13, s[32:35], s61 offen nt
    s_mov_b32 s61, 32768
    buffer_load_dwordx4 v[80:83], v13, s[32:35], s61 offen nt
    s_mov_b32 s61, 40960
    buffer_load_dwordx4 v[84:87], v13, s[32:35], s61 offen nt
    s_mov_b32 s61, 49152
    buffer_load_dwordx4 v[88:91], v13, s[32:35], s61 offen nt
    s_mov_b32 s61, 57344
    buffer_load_dwordx4 v[92:95], v13, s[32:35], s61 offen nt
    s_mov_b32 s61, 0
    buffer_load_dwordx4 v[96:99], v14, s[32:35], s61 offen nt
    s_mov_b32 s61, 8192
    buffer_load_dwordx4 v[100:103], v14, s[32:35], s61 offen nt
    s_mov_b32 s61, 16384
    buffer_load_dwordx4 v[104:107], v14, s[32:35], s61 offen nt
    s_mov_b32 s61, 24576
    buffer_load_dwordx4 v[108:111], v14, s[32:35], s61 offen nt
    s_mov_b32 s61, 32768
    buffer_load_dwordx4 v[112:115], v14, s[32:35], s61 offen nt
    s_mov_b32 s61, 40960
    buffer_load_dwordx4 v[116:119], v14, s[32:35], s61 offen nt
    s_mov_b32 s61, 49152
    buffer_load_dwordx4 v[120:123], v14, s[32:35], s61 offen nt
    s_mov_b32 s61, 57344
    buffer_load_dwordx4 v[124:127], v14, s[32:35], s61 offen nt
    s_mov_b32 s61, 0
    buffer_load_dwordx4 v[128:131], v15, s[32:35], s61 offen nt
    s_mov_b32 s61, 8192
    buffer_load_dwordx4 v[132:135], v15, s[32:35], s61 offen nt
    s_mov_b32 s61, 16384
    buffer_load_dwordx4 v[136:139], v15, s[32:35], s61 offen nt
    s_mov_b32 s61, 24576
    buffer_load_dwordx4 v[140:143], v15, s[32:35], s61 offen nt
    s_mov_b32 s61, 32768
    buffer_load_dwordx4 v[144:147], v15, s[32:35], s61 offen nt
    s_mov_b32 s61, 40960
    buffer_load_dwordx4 v[148:151], v15, s[32:35], s61 offen nt
    s_mov_b32 s61, 49152
    buffer_load_dwordx4 v[152:155], v15, s[32:35], s61 offen nt
    s_mov_b32 s61, 57344
    buffer_load_dwordx4 v[156:159], v15, s[32:35], s61 offen nt
    s_waitcnt lgkmcnt(0)
    s_barrier
    s_waitcnt vmcnt(32)
    v_readfirstlane_b32 s53, v255
    v_cmp_gt_u32 vcc, 2, v5
    s_add_u32 s53, s53, 1
    s_and_b32 s53, s53, 0xfff
    v_cndmask_b32 v28, 0, v28, vcc
    v_cndmask_b32 v29, 0, v29, vcc
    v_cndmask_b32 v30, 0, v30, vcc
    v_cndmask_b32 v31, 0, v31, vcc
    s_getreg_b32 s93, hwreg(HW_REG_XCC_ID)
    s_and_b32 s93, s93, 0xff
    s_lshl_b32 s93, s93, 12
    s_or_b32 s93, s93, s53
    s_waitcnt vmcnt(24)
    v_perm_b32 v160, v36, v32, s82
    v_perm_b32 v161, v44, v40, s82
    v_perm_b32 v162, v52, v48, s82
    v_perm_b32 v163, v60, v56, s82
    v_perm_b32 v164, v36, v32, s83
    v_perm_b32 v165, v44, v40, s83
    v_perm_b32 v166, v52, v48, s83
    v_perm_b32 v167, v60, v56, s83
    v_perm_b32 v168, v37, v33, s82
    v_perm_b32 v169, v45, v41, s82
    v_perm_b32 v170, v53, v49, s82
    v_perm_b32 v171, v61, v57, s82
    v_perm_b32 v172, v37, v33, s83
    v_perm_b32 v173, v45, v41, s83
    v_perm_b32 v174, v53, v49, s83
    v_perm_b32 v175, v61, v57, s83
    v_perm_b32 v176, v38, v34, s82
    v_perm_b32 v177, v46, v42, s82
    v_perm_b32 v178, v54, v50, s82
    v_perm_b32 v179, v62, v58, s82
    v_perm_b32 v180, v38, v34, s83
    v_perm_b32 v181, v46, v42, s83
    v_perm_b32 v182, v54, v50, s83
    v_perm_b32 v183, v62, v58, s83
    v_perm_b32 v184, v39, v35, s82
    v_perm_b32 v185, v47, v43, s82
    v_perm_b32 v186, v55, v51, s82
    v_perm_b32 v187, v63, v59, s82
    v_perm_b32 v188, v39, v35, s83
    v_perm_b32 v189, v47, v43, s83
    v_perm_b32 v190, v55, v51, s83
    v_perm_b32 v191, v63, v59, s83
    s_nop 1
    v_mfma_f32_16x16x32_bf16 v[192:195], v[160:163], v[16:19], 0
    v_mfma_f32_16x16x32_bf16 v[196:199], v[164:167], v[16:19], 0
    v_mfma_f32_16x16x32_bf16 v[200:203], v[168:171], v[16:19], 0
    v_mfma_f32_16x16x32_bf16 v[204:207], v[172:175], v[16:19], 0
    v_mfma_f32_16x16x32_bf16 v[208:211], v[176:179], v[16:19], 0
    v_mfma_f32_16x16x32_bf16 v[212:215], v[180:183], v[16:19], 0
    v_mfma_f32_16x16x32_bf16 v[216:219], v[184:187], v[16:19], 0
    v_mfma_f32_16x16x32_bf16 v[220:223], v[188:191], v[16:19], 0
    s_waitcnt vmcnt(16)
    v_perm_b32 v160, v68, v64, s82
    v_perm_b32 v161, v76, v72, s82
    v_perm_b32 v162, v84, v80, s82
    v_perm_b32 v163, v92, v88, s82
    v_perm_b32 v164, v68, v64, s83
    v_perm_b32 v165, v76, v72, s83
    v_perm_b32 v166, v84, v80, s83
    v_perm_b32 v167, v92, v88, s83
    v_perm_b32 v168, v69, v65, s82
    v_perm_b32 v169, v77, v73, s82
    v_perm_b32 v170, v85, v81, s82
    v_perm_b32 v171, v93, v89, s82
    v_perm_b32 v172, v69, v65, s83
    v_perm_b32 v173, v77, v73, s83
    v_perm_b32 v174, v85, v81, s83
    v_perm_b32 v175, v93, v89, s83
    v_perm_b32 v176, v70, v66, s82
    v_perm_b32 v177, v78, v74, s82
    v_perm_b32 v178, v86, v82, s82
    v_perm_b32 v179, v94, v90, s82
    v_perm_b32 v180, v70, v66, s83
    v_perm_b32 v181, v78, v74, s83
    v_perm_b32 v182, v86, v82, s83
    v_perm_b32 v183, v94, v90, s83
    v_perm_b32 v184, v71, v67, s82
    v_perm_b32 v185, v79, v75, s82
    v_perm_b32 v186, v87, v83, s82
    v_perm_b32 v187, v95, v91, s82
    v_perm_b32 v188, v71, v67, s83
    v_perm_b32 v189, v79, v75, s83
    v_perm_b32 v190, v87, v83, s83
    v_perm_b32 v191, v95, v91, s83
    s_nop 1
    v_mfma_f32_16x16x32_bf16 v[192:195], v[160:163], v[20:23], v[192:195]
    v_mfma_f32_16x16x32_bf16 v[196:199], v[164:167], v[20:23], v[196:199]
    v_mfma_f32_16x16x32_bf16 v[200:203], v[168:171], v[20:23], v[200:203]
    v_mfma_f32_16x16x32_bf16 v[204:207], v[172:175], v[20:23], v[204:207]
    v_mfma_f32_16x16x32_bf16 v[208:211], v[176:179], v[20:23], v[208:211]
    v_mfma_f32_16x16x32_bf16 v[212:215], v[180:183], v[20:23], v[212:215]
    v_mfma_f32_16x16x32_bf16 v[216:219], v[184:187], v[20:23], v[216:219]
    v_mfma_f32_16x16x32_bf16 v[220:223], v[188:191], v[20:23], v[220:223]
    s_waitcnt vmcnt(8)
    v_perm_b32 v160, v100, v96, s82
    v_perm_b32 v161, v108, v104, s82
    v_perm_b32 v162, v116, v112, s82
    v_perm_b32 v163, v124, v120, s82
    v_perm_b32 v164, v100, v96, s83
    v_perm_b32 v165, v108, v104, s83
    v_perm_b32 v166, v116, v112, s83
    v_perm_b32 v167, v124, v120, s83
    v_perm_b32 v168, v101, v97, s82
    v_perm_b32 v169, v109, v105, s82
    v_perm_b32 v170, v117, v113, s82
    v_perm_b32 v171, v125, v121, s82
    v_perm_b32 v172, v101, v97, s83
    v_perm_b32 v173, v109, v105, s83
    v_perm_b32 v174, v117, v113, s83
    v_perm_b32 v175, v125, v121, s83
    v_perm_b32 v176, v102, v98, s82
    v_perm_b32 v177, v110, v106, s82
    v_perm_b32 v178, v118, v114, s82
    v_perm_b32 v179, v126, v122, s82
    v_perm_b32 v180, v102, v98, s83
    v_perm_b32 v181, v110, v106, s83
    v_perm_b32 v182, v118, v114, s83
    v_perm_b32 v183, v126, v122, s83
    v_perm_b32 v184, v103, v99, s82
    v_perm_b32 v185, v111, v107, s82
    v_perm_b32 v186, v119, v115, s82
    v_perm_b32 v187, v127, v123, s82
    v_perm_b32 v188, v103, v99, s83
    v_perm_b32 v189, v111, v107, s83
    v_perm_b32 v190, v119, v115, s83
    v_perm_b32 v191, v127, v123, s83
    s_nop 1
    v_mfma_f32_16x16x32_bf16 v[192:195], v[160:163], v[24:27], v[192:195]
    v_mfma_f32_16x16x32_bf16 v[196:199], v[164:167], v[24:27], v[196:199]
    v_mfma_f32_16x16x32_bf16 v[200:203], v[168:171], v[24:27], v[200:203]
    v_mfma_f32_16x16x32_bf16 v[204:207], v[172:175], v[24:27], v[204:207]
    v_mfma_f32_16x16x32_bf16 v[208:211], v[176:179], v[24:27], v[208:211]
    v_mfma_f32_16x16x32_bf16 v[212:215], v[180:183], v[24:27], v[212:215]
    v_mfma_f32_16x16x32_bf16 v[216:219], v[184:187], v[24:27], v[216:219]
    v_mfma_f32_16x16x32_bf16 v[220:223], v[188:191], v[24:27], v[220:223]
    s_waitcnt vmcnt(0)
    v_perm_b32 v160, v132, v128, s82
    v_perm_b32 v161, v140, v136, s82
    v_perm_b32 v162, v148, v144, s82
    v_perm_b32 v163, v156, v152, s82
    v_perm_b32 v164, v132, v128, s83
    v_perm_b32 v165, v140, v136, s83
    v_perm_b32 v166, v148, v144, s83
    v_perm_b32 v167, v156, v152, s83
    v_perm_b32 v168, v133, v129, s82
    v_perm_b32 v169, v141, v137, s82
    v_perm_b32 v170, v149, v145, s82
    v_perm_b32 v171, v157, v153, s82
    v_perm_b32 v172, v133, v129, s83
    v_perm_b32 v173, v141, v137, s83
    v_perm_b32 v174, v149, v145, s83
    v_perm_b32 v175, v157, v153, s83
    v_perm_b32 v176, v134, v130, s82
    v_perm_b32 v177, v142, v138, s82
    v_perm_b32 v178, v150, v146, s82
    v_perm_b32 v179, v158, v154, s82
    v_perm_b32 v180, v134, v130, s83
    v_perm_b32 v181, v142, v138, s83
    v_perm_b32 v182, v150, v146, s83
    v_perm_b32 v183, v158, v154, s83
    v_perm_b32 v184, v135, v131, s82
    v_perm_b32 v185, v143, v139, s82
    v_perm_b32 v186, v151, v147, s82
    v_perm_b32 v187, v159, v155, s82
    v_perm_b32 v188, v135, v131, s83
    v_perm_b32 v189, v143, v139, s83
    v_perm_b32 v190, v151, v147, s83
    v_perm_b32 v191, v159, v155, s83
    s_nop 1
    v_mfma_f32_16x16x32_bf16 v[192:195], v[160:163], v[28:31], v[192:195]
    v_mfma_f32_16x16x32_bf16 v[196:199], v[164:167], v[28:31], v[196:199]
    v_mfma_f32_16x16x32_bf16 v[200:203], v[168:171], v[28:31], v[200:203]
    v_mfma_f32_16x16x32_bf16 v[204:207], v[172:175], v[28:31], v[204:207]
    v_mfma_f32_16x16x32_bf16 v[208:211], v[176:179], v[28:31], v[208:211]
    v_mfma_f32_16x16x32_bf16 v[212:215], v[180:183], v[28:31], v[212:215]
    v_mfma_f32_16x16x32_bf16 v[216:219], v[184:187], v[28:31], v[216:219]
    v_mfma_f32_16x16x32_bf16 v[220:223], v[188:191], v[28:31], v[220:223]
    s_lshl_b32 s54, s81, 13
    s_add_u32 s54, s54, 131072
    v_lshlrev_b32 v9, 4, v4
    v_lshl_add_u32 v10, v5, 11, v9
    v_add_u32 v10, s54, v10
    s_nop 7
    v_or_b32 v192, 1, v192
    v_or_b32 v193, 1, v193
    v_or_b32 v194, 1, v194
    v_or_b32 v195, 1, v195
    v_or_b32 v196, 1, v196
    v_or_b32 v197, 1, v197
    v_or_b32 v198, 1, v198
    v_or_b32 v199, 1, v199
    v_or_b32 v200, 1, v200
    v_or_b32 v201, 1, v201
    v_or_b32 v202, 1, v202
    v_or_b32 v203, 1, v203
    v_or_b32 v204, 1, v204
    v_or_b32 v205, 1, v205
    v_or_b32 v206, 1, v206
    v_or_b32 v207, 1, v207
    v_or_b32 v208, 1, v208
    v_or_b32 v209, 1, v209
    v_or_b32 v210, 1, v210
    v_or_b32 v211, 1, v211
    v_or_b32 v212, 1, v212
    v_or_b32 v213, 1, v213
    v_or_b32 v214, 1, v214
    v_or_b32 v215, 1, v215
    v_or_b32 v216, 1, v216
    v_or_b32 v217, 1, v217
    v_or_b32 v218, 1, v218
    v_or_b32 v219, 1, v219
    v_or_b32 v220, 1, v220
    v_or_b32 v221, 1, v221
    v_or_b32 v222, 1, v222
    v_or_b32 v223, 1, v223
    ds_write_b128 v10, v[192:195] offset:0
    ds_write_b128 v10, v[196:199] offset:256
    ds_write_b128 v10, v[200:203] offset:512
    ds_write_b128 v10, v[204:207] offset:768
    ds_write_b128 v10, v[208:211] offset:1024
    ds_write_b128 v10, v[212:215] offset:1280
    ds_write_b128 v10, v[216:219] offset:1536
    ds_write_b128 v10, v[220:223] offset:1792
    s_lshl_b32 s54, s81, 11
    s_add_u32 s54, s54, 131072
    v_lshl_add_u32 v10, v5, 2, v9
    v_add_u32 v10, s54, v10
    s_mov_b32 s62, 160000
spin_1:
    ds_read_b32 v32, v10 offset:0
    ds_read_b32 v33, v10 offset:256
    ds_read_b32 v34, v10 offset:512
    ds_read_b32 v35, v10 offset:768
    ds_read_b32 v36, v10 offset:1024
    ds_read_b32 v37, v10 offset:1280
    ds_read_b32 v38, v10 offset:1536
    ds_read_b32 v39, v10 offset:1792
    ds_read_b32 v40, v10 offset:8192
    ds_read_b32 v41, v10 offset:8448
    ds_read_b32 v42, v10 offset:8704
    ds_read_b32 v43, v10 offset:8960
    ds_read_b32 v44, v10 offset:9216
    ds_read_b32 v45, v10 offset:9472
    ds_read_b32 v46, v10 offset:9728
    ds_read_b32 v47, v10 offset:9984
    ds_read_b32 v48, v10 offset:16384
    ds_read_b32 v49, v10 offset:16640
    ds_read_b32 v50, v10 offset:16896
    ds_read_b32 v51, v10 offset:17152
    ds_read_b32 v52, v10 offset:17408
    ds_read_b32 v53, v10 offset:17664
    ds_read_b32 v54, v10 offset:17920
    ds_read_b32 v55, v10 offset:18176
    ds_read_b32 v56, v10 offset:24576
    ds_read_b32 v57, v10 offset:24832
    ds_read_b32 v58, v10 offset:25088
    ds_read_b32 v59, v10 offset:25344
    ds_read_b32 v60, v10 offset:25600
    ds_read_b32 v61, v10 offset:25856
    ds_read_b32 v62, v10 offset:26112
    ds_read_b32 v63, v10 offset:26368
    s_waitcnt lgkmcnt(0)
    v_and_b32 v1, v32, v33
    v_and_b32 v1, v1, v34
    v_and_b32 v1, v1, v35
    v_and_b32 v1, v1, v36
    v_and_b32 v1, v1, v37
    v_and_b32 v1, v1, v38
    v_and_b32 v1, v1, v39
    v_and_b32 v1, v1, v40
    v_and_b32 v1, v1, v41
    v_and_b32 v1, v1, v42
    v_and_b32 v1, v1, v43
    v_and_b32 v1, v1, v44
    v_and_b32 v1, v1, v45
    v_and_b32 v1, v1, v46
    v_and_b32 v1, v1, v47
    v_and_b32 v1, v1, v48
    v_and_b32 v1, v1, v49
    v_and_b32 v1, v1, v50
    v_and_b32 v1, v1, v51
    v_and_b32 v1, v1, v52
    v_and_b32 v1, v1, v53
    v_and_b32 v1, v1, v54
    v_and_b32 v1, v1, v55
    v_and_b32 v1, v1, v56
    v_and_b32 v1, v1, v57
    v_and_b32 v1, v1, v58
    v_and_b32 v1, v1, v59
    v_and_b32 v1, v1, v60
    v_and_b32 v1, v1, v61
    v_and_b32 v1, v1, v62
    v_and_b32 v1, v1, v63
    v_and_b32 v1, 1, v1
    v_cmp_eq_u32 vcc, 0, v1
    s_nop 4
    s_cbranch_vccz spind_2
    s_sub_u32 s62, s62, 1
    s_cmp_lg_u32 s62, 0
    s_cbranch_scc1 spin_1
spind_2:
    s_lshl_b32 s54, s52, 15
    s_add_u32 s54, s54, 65536
    s_and_b32 s55, s50, 1
    s_lshl_b32 s55, s55, 14
    s_lshl_b32 s56, s81, 12
    s_add_u32 s55, s55, s56
    s_lshr_b32 s56, s50, 1
    s_lshl_b32 s56, s56, 8
    s_add_u32 s55, s55, s56
    s_add_u32 s55, s55, s54
    v_lshrrev_b32 v11, 1, v5
    v_lshl_add_u32 v11, v11, 11, v9
    v_and_b32 v12, 1, v5
    v_lshl_add_u32 v11, v12, 9, v11
    s_waitcnt lgkmcnt(0)
    v_add_f32 v32, v32, v40
    v_add_f32 v48, v48, v56
    v_add_f32 v33, v33, v41
    v_add_f32 v49, v49, v57
    v_add_f32 v34, v34, v42
    v_add_f32 v50, v50, v58
    v_add_f32 v35, v35, v43
    v_add_f32 v51, v51, v59
    v_add_f32 v36, v36, v44
    v_add_f32 v52, v52, v60
    v_add_f32 v37, v37, v45
    v_add_f32 v53, v53, v61
    v_add_f32 v38, v38, v46
    v_add_f32 v54, v54, v62
    v_add_f32 v39, v39, v47
    v_add_f32 v55, v55, v63
    v_add_f32 v32, v32, v48
    v_add_f32 v33, v33, v49
    v_add_f32 v34, v34, v50
    v_add_f32 v35, v35, v51
    v_add_f32 v36, v36, v52
    v_add_f32 v37, v37, v53
    v_add_f32 v38, v38, v54
    v_add_f32 v39, v39, v55
    v_cvt_pk_bf16_f32 v32, 0, v32
    v_cvt_pk_bf16_f32 v33, 0, v33
    v_cvt_pk_bf16_f32 v34, 0, v34
    v_cvt_pk_bf16_f32 v35, 0, v35
    v_cvt_pk_bf16_f32 v36, 0, v36
    v_cvt_pk_bf16_f32 v37, 0, v37
    v_cvt_pk_bf16_f32 v38, 0, v38
    v_cvt_pk_bf16_f32 v39, 0, v39
    v_or_b32 v32, s53, v32
    v_or_b32 v33, s53, v33
    v_or_b32 v34, s53, v34
    v_or_b32 v35, s53, v35
    v_or_b32 v36, s53, v36
    v_or_b32 v37, s53, v37
    v_or_b32 v38, s53, v38
    v_or_b32 v39, s53, v39
    buffer_store_dwordx4 v[32:35], v11, s[28:31], s55 offen sc1
    buffer_store_dwordx4 v[36:39], v11, s[28:31], s55 offen offset:1024 sc1
    s_lshl_b32 s55, s81, 13
    s_add_u32 s55, s55, s54
    v_lshlrev_b32 v12, 4, v0
    v_add_u32 v13, 4096, v12
    v_and_b32 v14, 1, v0
    v_lshlrev_b32 v14, 8, v14
    v_bfe_u32 v15, v0, 1, 1
    v_lshl_add_u32 v14, v15, 12, v14
    v_add_u32 v16, 3824, v14
    s_mov_b64 exec, 15
    s_mov_b32 s62, 40000
probe_3:
    buffer_load_dword v14, v16, s[28:31], s55 offen sc1
    s_waitcnt vmcnt(0)
    v_xor_b32 v14, s53, v14
    v_and_b32 v14, 0xfff, v14
    v_cmp_ne_u32 vcc, 0, v14
    s_nop 4
    s_cbranch_vccz prdone_4
    s_sub_u32 s62, s62, 1
    s_cmp_lg_u32 s62, 0
    s_cbranch_scc1 probe_3
prdone_4:
    s_mov_b64 exec, -1
    s_mov_b32 s62, 40000
poll_5:
    buffer_load_dwordx4 v[64:67], v12, s[28:31], s55 offen offset:0 sc1
    buffer_load_dwordx4 v[68:71], v12, s[28:31], s55 offen offset:1024 sc1
    buffer_load_dwordx4 v[72:75], v12, s[28:31], s55 offen offset:2048 sc1
    buffer_load_dwordx4 v[76:79], v12, s[28:31], s55 offen offset:3072 sc1
    buffer_load_dwordx4 v[80:83], v13, s[28:31], s55 offen offset:0 sc1
    buffer_load_dwordx4 v[84:87], v13, s[28:31], s55 offen offset:1024 sc1
    buffer_load_dwordx4 v[88:91], v13, s[28:31], s55 offen offset:2048 sc1
    buffer_load_dwordx4 v[92:95], v13, s[28:31], s55 offen offset:3072 sc1
    s_waitcnt vmcnt(0)
    v_xor_b32 v14, s53, v64
    v_xor_b32 v15, s53, v65
    v_or_b32 v14, v14, v15
    v_xor_b32 v15, s53, v66
    v_or_b32 v14, v14, v15
    v_xor_b32 v15, s53, v67
    v_or_b32 v14, v14, v15
    v_xor_b32 v15, s53, v68
    v_or_b32 v14, v14, v15
    v_xor_b32 v15, s53, v69
    v_or_b32 v14, v14, v15
    v_xor_b32 v15, s53, v70
    v_or_b32 v14, v14, v15
    v_xor_b32 v15, s53, v71
    v_or_b32 v14, v14, v15
    v_xor_b32 v15, s53, v72
    v_or_b32 v14, v14, v15
    v_xor_b32 v15, s53, v73
    v_or_b32 v14, v14, v15
    v_xor_b32 v15, s53, v74
    v_or_b32 v14, v14, v15
    v_xor_b32 v15, s53, v75
    v_or_b32 v14, v14, v15
    v_xor_b32 v15, s53, v76
    v_or_b32 v14, v14, v15
    v_xor_b32 v15, s53, v77
    v_or_b32 v14, v14, v15
    v_xor_b32 v15, s53, v78
    v_or_b32 v14, v14, v15
    v_xor_b32 v15, s53, v79
    v_or_b32 v14, v14, v15
    v_xor_b32 v15, s53, v80
    v_or_b32 v14, v14, v15
    v_xor_b32 v15, s53, v81
    v_or_b32 v14, v14, v15
    v_xor_b32 v15, s53, v82
    v_or_b32 v14, v14, v15
    v_xor_b32 v15, s53, v83
    v_or_b32 v14, v14, v15
    v_xor_b32 v15, s53, v84
    v_or_b32 v14, v14, v15
    v_xor_b32 v15, s53, v85
    v_or_b32 v14, v14, v15
    v_xor_b32 v15, s53, v86
    v_or_b32 v14, v14, v15
    v_xor_b32 v15, s53, v87
    v_or_b32 v14, v14, v15
    v_xor_b32 v15, s53, v88
    v_or_b32 v14, v14, v15
    v_xor_b32 v15, s53, v89
    v_or_b32 v14, v14, v15
    v_xor_b32 v15, s53, v90
    v_or_b32 v14, v14, v15
    v_xor_b32 v15, s53, v91
    v_or_b32 v14, v14, v15
    v_xor_b32 v15, s53, v92
    v_or_b32 v14, v14, v15
    v_xor_b32 v15, s53, v93
    v_or_b32 v14, v14, v15
    v_xor_b32 v15, s53, v94
    v_or_b32 v14, v14, v15
    v_xor_b32 v15, s53, v95
    v_or_b32 v14, v14, v15
    v_and_b32 v14, 0xfff, v14
    v_cmp_ne_u32 vcc, 0, v14
    s_nop 4
    s_cbranch_vccz pdone_6
    s_sub_u32 s62, s62, 1
    s_cmp_lg_u32 s62, 0
    s_cbranch_scc1 poll_5
pdone_6:
    s_lshl_b32 s54, s81, 12
    s_add_u32 s54, s54, 131072
    v_add_u32 v13, s54, v12
    v_perm_b32 v96, v65, v64, s83
    v_perm_b32 v97, v67, v66, s83
    v_perm_b32 v98, v69, v68, s83
    v_perm_b32 v99, v71, v70, s83
    ds_write_b128 v13, v[96:99] offset:0
    v_perm_b32 v100, v73, v72, s83
    v_perm_b32 v101, v75, v74, s83
    v_perm_b32 v102, v77, v76, s83
    v_perm_b32 v103, v79, v78, s83
    ds_write_b128 v13, v[100:103] offset:1024
    v_perm_b32 v104, v81, v80, s83
    v_perm_b32 v105, v83, v82, s83
    v_perm_b32 v106, v85, v84, s83
    v_perm_b32 v107, v87, v86, s83
    ds_write_b128 v13, v[104:107] offset:2048
    v_perm_b32 v108, v89, v88, s83
    v_perm_b32 v109, v91, v90, s83
    v_perm_b32 v110, v93, v92, s83
    v_perm_b32 v111, v95, v94, s83
    ds_write_b128 v13, v[108:111] offset:3072
    s_waitcnt lgkmcnt(0)
    s_barrier
    s_lshl_b32 s54, s49, 9
    s_lshl_b32 s55, s50, 6
    s_add_u32 s54, s54, s55
    s_mul_i32 s54, s54, 896
    s_mul_i32 s55, s81, 224
    s_add_u32 s54, s54, s55
    v_min_u32 v7, 13, v4
    v_lshlrev_b32 v7, 4, v7
    v_mul_u32_u24 v8, 7168, v5
    v_add_u32 v7, v7, v8
    v_add_u32 v7, s54, v7
    s_mul_i32 s55, s51, 0
    s_add_u32 s55, s55, 0
    s_and_b32 s55, s55, 3
    s_lshl_b32 s88, s55, 10
    s_lshr_b32 s56, s55, 1
    s_lshl_b32 s56, s56, 8
    s_and_b32 s55, s55, 1
    s_lshl_b32 s55, s55, 5
    s_add_u32 s55, s55, s56
    s_mul_i32 s84, s55, 896
    s_mul_i32 s55, s51, 0
    s_add_u32 s55, s55, 1
    s_and_b32 s55, s55, 3
    s_lshl_b32 s89, s55, 10
    s_lshr_b32 s56, s55, 1
    s_lshl_b32 s56, s56, 8
    s_and_b32 s55, s55, 1
    s_lshl_b32 s55, s55, 5
    s_add_u32 s55, s55, s56
    s_mul_i32 s85, s55, 896
    s_mul_i32 s55, s51, 0
    s_add_u32 s55, s55, 2
    s_and_b32 s55, s55, 3
    s_lshl_b32 s90, s55, 10
    s_lshr_b32 s56, s55, 1
    s_lshl_b32 s56, s56, 8
    s_and_b32 s55, s55, 1
    s_lshl_b32 s55, s55, 5
    s_add_u32 s55, s55, s56
    s_mul_i32 s86, s55, 896
    s_mul_i32 s55, s51, 0
    s_add_u32 s55, s55, 3
    s_and_b32 s55, s55, 3
    s_lshl_b32 s91, s55, 10
    s_lshr_b32 s56, s55, 1
    s_lshl_b32 s56, s56, 8
    s_and_b32 s55, s55, 1
    s_lshl_b32 s55, s55, 5
    s_add_u32 s55, s55, s56
    s_mul_i32 s87, s55, 896
    s_add_u32 s61, s84, 0
    buffer_load_dwordx4 v[160:163], v7, s[36:39], s61 offen nt
    s_add_u32 s61, s84, 896
    buffer_load_dwordx4 v[164:167], v7, s[36:39], s61 offen nt
    s_add_u32 s61, s84, 1792
    buffer_load_dwordx4 v[168:171], v7, s[36:39], s61 offen nt
    s_add_u32 s61, s84, 2688
    buffer_load_dwordx4 v[172:175], v7, s[36:39], s61 offen nt
    s_add_u32 s61, s84, 3584
    buffer_load_dwordx4 v[176:179], v7, s[36:39], s61 offen nt
    s_add_u32 s61, s84, 4480
    buffer_load_dwordx4 v[180:183], v7, s[36:39], s61 offen nt
    s_add_u32 s61, s84, 5376
    buffer_load_dwordx4 v[184:187], v7, s[36:39], s61 offen nt
    s_add_u32 s61, s84, 6272
    buffer_load_dwordx4 v[188:191], v7, s[36:39], s61 offen nt
    s_add_u32 s61, s85, 0
    buffer_load_dwordx4 v[192:195], v7, s[36:39], s61 offen nt
    s_add_u32 s61, s85, 896
    buffer_load_dwordx4 v[196:199], v7, s[36:39], s61 offen nt
    s_add_u32 s61, s85, 1792
    buffer_load_dwordx4 v[200:203], v7, s[36:39], s61 offen nt
    s_add_u32 s61, s85, 2688
    buffer_load_dwordx4 v[204:207], v7, s[36:39], s61 offen nt
    s_add_u32 s61, s85, 3584
    buffer_load_dwordx4 v[208:211], v7, s[36:39], s61 offen nt
    s_add_u32 s61, s85, 4480
    buffer_load_dwordx4 v[212:215], v7, s[36:39], s61 offen nt
    s_add_u32 s61, s85, 5376
    buffer_load_dwordx4 v[216:219], v7, s[36:39], s61 offen nt
    s_add_u32 s61, s85, 6272
    buffer_load_dwordx4 v[220:223], v7, s[36:39], s61 offen nt
    s_barrier
    v_and_b32 v8, 31, v0
    v_lshlrev_b32 v9, 2, v8
    v_add_u32 v3, 0x10000, v9
    ds_read_b32 v224, v9 offset:24576
    ds_read_b32 v225, v9 offset:57344
    ds_read_b32 v226, v3 offset:24576
    ds_read_b32 v227, v3 offset:57344
    s_waitcnt lgkmcnt(0)
    v_max3_f32 v228, v224, v225, v226
    v_max_f32 v228, v228, v227
    s_barrier
    s_cmp_lg_u32 s81, 0
    s_cbranch_scc1 NOSTAT0
    ds_read_b32 v224, v9 offset:24704
    ds_read_b32 v225, v9 offset:57472
    ds_read_b32 v226, v3 offset:24704
    ds_read_b32 v227, v3 offset:57472
    s_lshl_b32 s54, s52, 11
    s_add_u32 s54, s54, 3145728
    s_lshl_b32 s55, s50, 9
    s_add_u32 s55, s55, s54
    v_lshlrev_b32 v10, 4, v8
    v_mov_b32 v230, s53
    v_mov_b32 v231, s93
    s_waitcnt lgkmcnt(0)
    v_add_f32 v224, v224, v225
    v_add_f32 v226, v226, v227
    v_add_f32 v229, v224, v226
    s_nop 1
    buffer_store_dwordx4 v[228:231], v10, s[28:31], s55 offen sc1
NOSTAT0:
    s_waitcnt vmcnt(8)
    v_perm_b32 v32, v164, v160, s82
    v_perm_b32 v33, v172, v168, s82
    v_perm_b32 v34, v180, v176, s82
    v_perm_b32 v35, v188, v184, s82
    v_perm_b32 v36, v164, v160, s83
    v_perm_b32 v37, v172, v168, s83
    v_perm_b32 v38, v180, v176, s83
    v_perm_b32 v39, v188, v184, s83
    v_perm_b32 v40, v165, v161, s82
    v_perm_b32 v41, v173, v169, s82
    v_perm_b32 v42, v181, v177, s82
    v_perm_b32 v43, v189, v185, s82
    v_perm_b32 v44, v165, v161, s83
    v_perm_b32 v45, v173, v169, s83
    v_perm_b32 v46, v181, v177, s83
    v_perm_b32 v47, v189, v185, s83
    v_perm_b32 v48, v166, v162, s82
    v_perm_b32 v49, v174, v170, s82
    v_perm_b32 v50, v182, v178, s82
    v_perm_b32 v51, v190, v186, s82
    v_perm_b32 v52, v166, v162, s83
    v_perm_b32 v53, v174, v170, s83
    v_perm_b32 v54, v182, v178, s83
    v_perm_b32 v55, v190, v186, s83
    v_perm_b32 v56, v167, v163, s82
    v_perm_b32 v57, v175, v171, s82
    v_perm_b32 v58, v183, v179, s82
    v_perm_b32 v59, v191, v187, s82
    v_perm_b32 v60, v167, v163, s83
    v_perm_b32 v61, v175, v171, s83
    v_perm_b32 v62, v183, v179, s83
    v_perm_b32 v63, v191, v187, s83
    s_waitcnt vmcnt(0)
    v_perm_b32 v64, v196, v192, s82
    v_perm_b32 v65, v204, v200, s82
    v_perm_b32 v66, v212, v208, s82
    v_perm_b32 v67, v220, v216, s82
    v_perm_b32 v68, v196, v192, s83
    v_perm_b32 v69, v204, v200, s83
    v_perm_b32 v70, v212, v208, s83
    v_perm_b32 v71, v220, v216, s83
    v_perm_b32 v72, v197, v193, s82
    v_perm_b32 v73, v205, v201, s82
    v_perm_b32 v74, v213, v209, s82
    v_perm_b32 v75, v221, v217, s82
    v_perm_b32 v76, v197, v193, s83
    v_perm_b32 v77, v205, v201, s83
    v_perm_b32 v78, v213, v209, s83
    v_perm_b32 v79, v221, v217, s83
    v_perm_b32 v80, v198, v194, s82
    v_perm_b32 v81, v206, v202, s82
    v_perm_b32 v82, v214, v210, s82
    v_perm_b32 v83, v222, v218, s82
    v_perm_b32 v84, v198, v194, s83
    v_perm_b32 v85, v206, v202, s83
    v_perm_b32 v86, v214, v210, s83
    v_perm_b32 v87, v222, v218, s83
    v_perm_b32 v88, v199, v195, s82
    v_perm_b32 v89, v207, v203, s82
    v_perm_b32 v90, v215, v211, s82
    v_perm_b32 v91, v223, v219, s82
    v_perm_b32 v92, v199, v195, s83
    v_perm_b32 v93, v207, v203, s83
    v_perm_b32 v94, v215, v211, s83
    v_perm_b32 v95, v223, v219, s83
    s_add_u32 s61, s86, 0
    buffer_load_dwordx4 v[160:163], v7, s[36:39], s61 offen nt
    s_add_u32 s61, s86, 896
    buffer_load_dwordx4 v[164:167], v7, s[36:39], s61 offen nt
    s_add_u32 s61, s86, 1792
    buffer_load_dwordx4 v[168:171], v7, s[36:39], s61 offen nt
    s_add_u32 s61, s86, 2688
    buffer_load_dwordx4 v[172:175], v7, s[36:39], s61 offen nt
    s_add_u32 s61, s86, 3584
    buffer_load_dwordx4 v[176:179], v7, s[36:39], s61 offen nt
    s_add_u32 s61, s86, 4480
    buffer_load_dwordx4 v[180:183], v7, s[36:39], s61 offen nt
    s_add_u32 s61, s86, 5376
    buffer_load_dwordx4 v[184:187], v7, s[36:39], s61 offen nt
    s_add_u32 s61, s86, 6272
    buffer_load_dwordx4 v[188:191], v7, s[36:39], s61 offen nt
    s_add_u32 s61, s87, 0
    buffer_load_dwordx4 v[192:195], v7, s[36:39], s61 offen nt
    s_add_u32 s61, s87, 896
    buffer_load_dwordx4 v[196:199], v7, s[36:39], s61 offen nt
    s_add_u32 s61, s87, 1792
    buffer_load_dwordx4 v[200:203], v7, s[36:39], s61 offen nt
    s_add_u32 s61, s87, 2688
    buffer_load_dwordx4 v[204:207], v7, s[36:39], s61 offen nt
    s_add_u32 s61, s87, 3584
    buffer_load_dwordx4 v[208:211], v7, s[36:39], s61 offen nt
    s_add_u32 s61, s87, 4480
    buffer_load_dwordx4 v[212:215], v7, s[36:39], s61 offen nt
    s_add_u32 s61, s87, 5376
    buffer_load_dwordx4 v[216:219], v7, s[36:39], s61 offen nt
    s_add_u32 s61, s87, 6272
    buffer_load_dwordx4 v[220:223], v7, s[36:39], s61 offen nt
    s_cmp_lg_u32 s81, 0
    s_cbranch_scc1 NOSTAT
    s_lshl_b32 s54, s52, 11
    s_add_u32 s54, s54, 3145728
    s_mov_b32 s62, 40000
poll_7:
    buffer_load_dwordx4 v[232:235], v10, s[28:31], s54 offen offset:0 sc1
    buffer_load_dwordx4 v[236:239], v10, s[28:31], s54 offen offset:512 sc1
    buffer_load_dwordx4 v[240:243], v10, s[28:31], s54 offen offset:1024 sc1
    buffer_load_dwordx4 v[244:247], v10, s[28:31], s54 offen offset:1536 sc1
    s_waitcnt vmcnt(0)
    v_xor_b32 v14, s53, v234
    v_xor_b32 v15, s53, v235
    v_or_b32 v14, v14, v15
    v_xor_b32 v15, s53, v238
    v_or_b32 v14, v14, v15
    v_xor_b32 v15, s53, v239
    v_or_b32 v14, v14, v15
    v_xor_b32 v15, s53, v242
    v_or_b32 v14, v14, v15
    v_xor_b32 v15, s53, v243
    v_or_b32 v14, v14, v15
    v_xor_b32 v15, s53, v246
    v_or_b32 v14, v14, v15
    v_xor_b32 v15, s53, v247
    v_or_b32 v14, v14, v15
    v_and_b32 v14, 0xfff, v14
    v_cmp_ne_u32 vcc, 0, v14
    s_nop 4
    s_cbranch_vccz pdone_8
    s_sub_u32 s62, s62, 1
    s_cmp_lg_u32 s62, 0
    s_cbranch_scc1 poll_7
pdone_8:
    s_mov_b32 s54, 0x3db8aa3b
    v_max3_f32 v224, v232, v236, v240
    v_max_f32 v224, v224, v244
    v_sub_f32 v232, v232, v224
    v_mul_f32 v232, s54, v232
    v_exp_f32 v232, v232
    v_sub_f32 v236, v236, v224
    v_mul_f32 v236, s54, v236
    v_exp_f32 v236, v236
    v_sub_f32 v240, v240, v224
    v_mul_f32 v240, s54, v240
    v_exp_f32 v240, v240
    v_sub_f32 v244, v244, v224
    v_mul_f32 v244, s54, v244
    v_exp_f32 v244, v244
    v_sub_f32 v225, v228, v224
    v_mul_f32 v225, s54, v225
    v_exp_f32 v225, v225
    v_mul_f32 v226, v232, v233
    v_fma_f32 v226, v236, v237, v226
    v_fma_f32 v226, v240, v241, v226
    v_fma_f32 v226, v244, v245, v226
    v_rcp_f32 v226, v226
    s_nop 1
    v_mul_f32 v225, v225, v226
    v_xor_b32 v226, s93, v235
    v_xor_b32 v227, s93, v239
    v_or_b32 v226, v226, v227
    v_xor_b32 v227, s93, v243
    v_or_b32 v226, v226, v227
    v_xor_b32 v227, s93, v247
    v_or_b32 v226, v226, v227
    v_cmp_ne_u32 vcc, 0, v226
    s_nop 4
    s_cmp_eq_u64 vcc, 0
    s_cselect_b32 s92, 1, 0
    v_mov_b32 v226, s92
    ds_write_b32 v9, v225 offset:24832
    ds_write_b32 v9, v226 offset:24960
    s_waitcnt lgkmcnt(0)
NOSTAT:
    s_setprio 3
    s_waitcnt vmcnt(8)
    v_perm_b32 v96, v164, v160, s82
    v_perm_b32 v97, v172, v168, s82
    v_perm_b32 v98, v180, v176, s82
    v_perm_b32 v99, v188, v184, s82
    v_perm_b32 v100, v164, v160, s83
    v_perm_b32 v101, v172, v168, s83
    v_perm_b32 v102, v180, v176, s83
    v_perm_b32 v103, v188, v184, s83
    v_perm_b32 v104, v165, v161, s82
    v_perm_b32 v105, v173, v169, s82
    v_perm_b32 v106, v181, v177, s82
    v_perm_b32 v107, v189, v185, s82
    v_perm_b32 v108, v165, v161, s83
    v_perm_b32 v109, v173, v169, s83
    v_perm_b32 v110, v181, v177, s83
    v_perm_b32 v111, v189, v185, s83
    v_perm_b32 v112, v166, v162, s82
    v_perm_b32 v113, v174, v170, s82
    v_perm_b32 v114, v182, v178, s82
    v_perm_b32 v115, v190, v186, s82
    v_perm_b32 v116, v166, v162, s83
    v_perm_b32 v117, v174, v170, s83
    v_perm_b32 v118, v182, v178, s83
    v_perm_b32 v119, v190, v186, s83
    v_perm_b32 v120, v167, v163, s82
    v_perm_b32 v121, v175, v171, s82
    v_perm_b32 v122, v183, v179, s82
    v_perm_b32 v123, v191, v187, s82
    v_perm_b32 v124, v167, v163, s83
    v_perm_b32 v125, v175, v171, s83
    v_perm_b32 v126, v183, v179, s83
    v_perm_b32 v127, v191, v187, s83
    s_waitcnt vmcnt(0)
    v_perm_b32 v128, v196, v192, s82
    v_perm_b32 v129, v204, v200, s82
    v_perm_b32 v130, v212, v208, s82
    v_perm_b32 v131, v220, v216, s82
    v_perm_b32 v132, v196, v192, s83
    v_perm_b32 v133, v204, v200, s83
    v_perm_b32 v134, v212, v208, s83
    v_perm_b32 v135, v220, v216, s83
    v_perm_b32 v136, v197, v193, s82
    v_perm_b32 v137, v205, v201, s82
    v_perm_b32 v138, v213, v209, s82
    v_perm_b32 v139, v221, v217, s82
    v_perm_b32 v140, v197, v193, s83
    v_perm_b32 v141, v205, v201, s83
    v_perm_b32 v142, v213, v209, s83
    v_perm_b32 v143, v221, v217, s83
    v_perm_b32 v144, v198, v194, s82
    v_perm_b32 v145, v206, v202, s82
    v_perm_b32 v146, v214, v210, s82
    v_perm_b32 v147, v222, v218, s82
    v_perm_b32 v148, v198, v194, s83
    v_perm_b32 v149, v206, v202, s83
    v_perm_b32 v150, v214, v210, s83
    v_perm_b32 v151, v222, v218, s83
    v_perm_b32 v152, v199, v195, s82
    v_perm_b32 v153, v207, v203, s82
    v_perm_b32 v154, v215, v211, s82
    v_perm_b32 v155, v223, v219, s82
    v_perm_b32 v156, v199, v195, s83
    v_perm_b32 v157, v207, v203, s83
    v_perm_b32 v158, v215, v211, s83
    v_perm_b32 v159, v223, v219, s83
    s_barrier
    v_mov_b32 v224, 0
    ds_read_b32 v224, v224 offset:24960
    s_waitcnt lgkmcnt(0)
    v_readfirstlane_b32 s92, v224
    s_barrier
    s_lshl_b32 s54, s52, 17
    s_lshl_b32 s55, s50, 15
    s_add_u32 s54, s54, s55
    s_lshl_b32 s55, s81, 10
    s_add_u32 s54, s54, s55
    s_add_u32 s54, s54, 4194304
    v_lshlrev_b32 v2, 4, v0
    s_add_u32 s55, s55, 131072
    v_add_u32 v3, s55, v2
    ds_read_b128 v[184:187], v3
    ds_read_b128 v[188:191], v3 offset:4096
    v_add_u32 v6, 4096, v2
    s_add_u32 s55, s50, 1
    s_and_b32 s55, s55, 3
    s_lshl_b32 s55, s55, 13
    s_add_u32 s55, s55, s54
    s_add_u32 s56, s50, 2
    s_and_b32 s56, s56, 3
    s_lshl_b32 s56, s56, 13
    s_add_u32 s56, s56, s54
    s_add_u32 s57, s50, 3
    s_and_b32 s57, s57, 3
    s_lshl_b32 s57, s57, 13
    s_add_u32 s57, s57, s54
    s_lshl_b32 s58, s81, 8
    s_add_u32 s58, s58, 139264
    v_and_b32 v4, 15, v0
    v_lshlrev_b32 v4, 4, v4
    v_bfe_u32 v5, v0, 4, 1
    v_lshl_add_u32 v4, v5, 11, v4
    v_lshrrev_b32 v5, 5, v0
    v_lshl_add_u32 v4, v5, 3, v4
    v_add_u32 v4, s58, v4
    v_add_u32 v14, s50, v0
    v_add_u32 v14, 1, v14
    v_and_b32 v14, 3, v14
    v_lshlrev_b32 v16, 4, v14
    s_lshl_b32 s59, s52, 8
    s_lshl_b32 s61, s50, 6
    s_add_u32 s59, s59, s61
    s_add_u32 s59, s59, 3670016
    v_lshlrev_b32 v16, 13, v14
    v_add_u32 v16, 5104, v16
    s_cmp_lg_u32 s92, 0
    s_cbranch_scc1 H1NP
    s_mov_b64 exec, 7
    s_mov_b32 s62, 40000
probe_9:
    buffer_load_dword v14, v16, s[28:31], s54 offen sc1
    s_waitcnt vmcnt(0)
    v_xor_b32 v14, s53, v14
    v_and_b32 v14, 0xfff, v14
    v_cmp_ne_u32 vcc, 0, v14
    s_nop 4
    s_cbranch_vccz prdone_10
    s_sub_u32 s62, s62, 1
    s_cmp_lg_u32 s62, 0
    s_cbranch_scc1 probe_9
prdone_10:
    s_mov_b64 exec, -1
H1NP:
    s_mov_b32 s62, 40000
poll_11:
    buffer_load_dwordx4 v[160:163], v2, s[28:31], s55 offen sc1
    buffer_load_dwordx4 v[164:167], v2, s[28:31], s56 offen sc1
    buffer_load_dwordx4 v[168:171], v2, s[28:31], s57 offen sc1
    buffer_load_dwordx4 v[172:175], v6, s[28:31], s55 offen sc1
    buffer_load_dwordx4 v[176:179], v6, s[28:31], s56 offen sc1
    buffer_load_dwordx4 v[180:183], v6, s[28:31], s57 offen sc1
    s_waitcnt vmcnt(0)
    v_xor_b32 v14, s53, v160
    v_xor_b32 v15, s53, v161
    v_or_b32 v14, v14, v15
    v_xor_b32 v15, s53, v162
    v_or_b32 v14, v14, v15
    v_xor_b32 v15, s53, v163
    v_or_b32 v14, v14, v15
    v_xor_b32 v15, s53, v164
    v_or_b32 v14, v14, v15
    v_xor_b32 v15, s53, v165
    v_or_b32 v14, v14, v15
    v_xor_b32 v15, s53, v166
    v_or_b32 v14, v14, v15
    v_xor_b32 v15, s53, v167
    v_or_b32 v14, v14, v15
    v_xor_b32 v15, s53, v168
    v_or_b32 v14, v14, v15
    v_xor_b32 v15, s53, v169
    v_or_b32 v14, v14, v15
    v_xor_b32 v15, s53, v170
    v_or_b32 v14, v14, v15
    v_xor_b32 v15, s53, v171
    v_or_b32 v14, v14, v15
    v_xor_b32 v15, s53, v172
    v_or_b32 v14, v14, v15
    v_xor_b32 v15, s53, v173
    v_or_b32 v14, v14, v15
    v_xor_b32 v15, s53, v174
    v_or_b32 v14, v14, v15
    v_xor_b32 v15, s53, v175
    v_or_b32 v14, v14, v15
    v_xor_b32 v15, s53, v176
    v_or_b32 v14, v14, v15
    v_xor_b32 v15, s53, v177
    v_or_b32 v14, v14, v15
    v_xor_b32 v15, s53, v178
    v_or_b32 v14, v14, v15
    v_xor_b32 v15, s53, v179
    v_or_b32 v14, v14, v15
    v_xor_b32 v15, s53, v180
    v_or_b32 v14, v14, v15
    v_xor_b32 v15, s53, v181
    v_or_b32 v14, v14, v15
    v_xor_b32 v15, s53, v182
    v_or_b32 v14, v14, v15
    v_xor_b32 v15, s53, v183
    v_or_b32 v14, v14, v15
    v_and_b32 v14, 0xfff, v14
    v_cmp_ne_u32 vcc, 0, v14
    s_nop 4
    s_cbranch_vccz pdone_12
    s_sub_u32 s62, s62, 1
    s_cmp_lg_u32 s62, 0
    s_cbranch_scc1 poll_11
pdone_12:
    s_waitcnt lgkmcnt(0)
    v_and_b32 v160, s80, v160
    v_and_b32 v164, s80, v164
    v_and_b32 v168, s80, v168
    v_add_f32 v160, v160, v164
    v_add_f32 v168, v168, v184
    v_add_f32 v160, v160, v168
    v_and_b32 v161, s80, v161
    v_and_b32 v165, s80, v165
    v_and_b32 v169, s80, v169
    v_add_f32 v161, v161, v165
    v_add_f32 v169, v169, v185
    v_add_f32 v161, v161, v169
    v_and_b32 v162, s80, v162
    v_and_b32 v166, s80, v166
    v_and_b32 v170, s80, v170
    v_add_f32 v162, v162, v166
    v_add_f32 v170, v170, v186
    v_add_f32 v162, v162, v170
    v_and_b32 v163, s80, v163
    v_and_b32 v167, s80, v167
    v_and_b32 v171, s80, v171
    v_add_f32 v163, v163, v167
    v_add_f32 v171, v171, v187
    v_add_f32 v163, v163, v171
    v_cvt_pk_bf16_f32 v160, v160, v161
    v_cvt_pk_bf16_f32 v161, v162, v163
    ds_write_b64 v4, v[160:161] offset:0
    v_and_b32 v172, s80, v172
    v_and_b32 v176, s80, v176
    v_and_b32 v180, s80, v180
    v_add_f32 v172, v172, v176
    v_add_f32 v180, v180, v188
    v_add_f32 v172, v172, v180
    v_and_b32 v173, s80, v173
    v_and_b32 v177, s80, v177
    v_and_b32 v181, s80, v181
    v_add_f32 v173, v173, v177
    v_add_f32 v181, v181, v189
    v_add_f32 v173, v173, v181
    v_and_b32 v174, s80, v174
    v_and_b32 v178, s80, v178
    v_and_b32 v182, s80, v182
    v_add_f32 v174, v174, v178
    v_add_f32 v182, v182, v190
    v_add_f32 v174, v174, v182
    v_and_b32 v175, s80, v175
    v_and_b32 v179, s80, v179
    v_and_b32 v183, s80, v183
    v_add_f32 v175, v175, v179
    v_add_f32 v183, v183, v191
    v_add_f32 v175, v175, v183
    v_cvt_pk_bf16_f32 v172, v172, v173
    v_cvt_pk_bf16_f32 v173, v174, v175
    ds_write_b64 v4, v[172:173] offset:1024
    s_waitcnt lgkmcnt(0)
    s_barrier
    v_add_u32 v3, 139264, v2
    v_add_u32 v8, s88, v3
    v_add_u32 v9, s89, v3
    v_add_u32 v10, s90, v3
    v_add_u32 v11, s91, v3
    ds_read_b128 v[160:163], v8
    ds_read_b128 v[164:167], v9
    ds_read_b128 v[168:171], v10
    ds_read_b128 v[172:175], v11
    s_lshl_b32 s54, s2, 6
    s_lshl_b32 s55, s81, 4
    s_add_u32 s54, s54, s55
    s_add_u32 s54, s54, 3735552
    v_mov_b32 v4, s53
    v_mov_b32 v5, 0
    s_mov_b64 exec, 1
    s_mov_b64 exec, -1
    s_waitcnt lgkmcnt(3)
    v_mfma_f32_16x16x32_bf16 v[192:195], v[32:35], v[160:163], 0
    v_mfma_f32_16x16x32_bf16 v[196:199], v[36:39], v[160:163], 0
    v_mfma_f32_16x16x32_bf16 v[200:203], v[40:43], v[160:163], 0
    v_mfma_f32_16x16x32_bf16 v[204:207], v[44:47], v[160:163], 0
    v_mfma_f32_16x16x32_bf16 v[208:211], v[48:51], v[160:163], 0
    v_mfma_f32_16x16x32_bf16 v[212:215], v[52:55], v[160:163], 0
    v_mfma_f32_16x16x32_bf16 v[216:219], v[56:59], v[160:163], 0
    v_mfma_f32_16x16x32_bf16 v[220:223], v[60:63], v[160:163], 0
    s_waitcnt lgkmcnt(2)
    v_mfma_f32_16x16x32_bf16 v[192:195], v[64:67], v[164:167], v[192:195]
    v_mfma_f32_16x16x32_bf16 v[196:199], v[68:71], v[164:167], v[196:199]
    v_mfma_f32_16x16x32_bf16 v[200:203], v[72:75], v[164:167], v[200:203]
    v_mfma_f32_16x16x32_bf16 v[204:207], v[76:79], v[164:167], v[204:207]
    v_mfma_f32_16x16x32_bf16 v[208:211], v[80:83], v[164:167], v[208:211]
    v_mfma_f32_16x16x32_bf16 v[212:215], v[84:87], v[164:167], v[212:215]
    v_mfma_f32_16x16x32_bf16 v[216:219], v[88:91], v[164:167], v[216:219]
    v_mfma_f32_16x16x32_bf16 v[220:223], v[92:95], v[164:167], v[220:223]
    s_waitcnt lgkmcnt(1)
    v_mfma_f32_16x16x32_bf16 v[192:195], v[96:99], v[168:171], v[192:195]
    v_mfma_f32_16x16x32_bf16 v[196:199], v[100:103], v[168:171], v[196:199]
    v_mfma_f32_16x16x32_bf16 v[200:203], v[104:107], v[168:171], v[200:203]
    v_mfma_f32_16x16x32_bf16 v[204:207], v[108:111], v[168:171], v[204:207]
    v_mfma_f32_16x16x32_bf16 v[208:211], v[112:115], v[168:171], v[208:211]
    v_mfma_f32_16x16x32_bf16 v[212:215], v[116:119], v[168:171], v[212:215]
    v_mfma_f32_16x16x32_bf16 v[216:219], v[120:123], v[168:171], v[216:219]
    v_mfma_f32_16x16x32_bf16 v[220:223], v[124:127], v[168:171], v[220:223]
    s_waitcnt lgkmcnt(0)
    v_mfma_f32_16x16x32_bf16 v[192:195], v[128:131], v[172:175], v[192:195]
    v_mfma_f32_16x16x32_bf16 v[196:199], v[132:135], v[172:175], v[196:199]
    v_mfma_f32_16x16x32_bf16 v[200:203], v[136:139], v[172:175], v[200:203]
    v_mfma_f32_16x16x32_bf16 v[204:207], v[140:143], v[172:175], v[204:207]
    v_mfma_f32_16x16x32_bf16 v[208:211], v[144:147], v[172:175], v[208:211]
    v_mfma_f32_16x16x32_bf16 v[212:215], v[148:151], v[172:175], v[212:215]
    v_mfma_f32_16x16x32_bf16 v[216:219], v[152:155], v[172:175], v[216:219]
    v_mfma_f32_16x16x32_bf16 v[220:223], v[156:159], v[172:175], v[220:223]
    s_mul_i32 s54, s2, 28672
    s_mul_i32 s55, s81, 7168
    s_add_u32 s54, s54, s55
    s_add_u32 s54, s54, 16777216
    v_and_b32 v4, 15, v0
    v_lshlrev_b32 v4, 4, v4
    v_lshrrev_b32 v5, 4, v0
    v_lshl_add_u32 v4, v5, 11, v4
    v_mov_b32 v6, s53
    s_nop 4
    v_add_u32 v160, 0x800, v192
    v_and_or_b32 v160, v160, s80, v6
    v_add_u32 v161, 0x800, v196
    v_and_or_b32 v161, v161, s80, v6
    v_add_u32 v162, 0x800, v200
    v_and_or_b32 v162, v162, s80, v6
    v_add_u32 v163, 0x800, v204
    v_and_or_b32 v163, v163, s80, v6
    buffer_store_dwordx4 v[160:163], v4, s[28:31], s54 offen offset:0 sc1
    v_add_u32 v164, 0x800, v208
    v_and_or_b32 v164, v164, s80, v6
    v_add_u32 v165, 0x800, v212
    v_and_or_b32 v165, v165, s80, v6
    v_add_u32 v166, 0x800, v216
    v_and_or_b32 v166, v166, s80, v6
    v_add_u32 v167, 0x800, v220
    v_and_or_b32 v167, v167, s80, v6
    buffer_store_dwordx4 v[164:167], v4, s[28:31], s54 offen offset:256 sc1
    v_add_u32 v168, 0x800, v193
    v_and_or_b32 v168, v168, s80, v6
    v_add_u32 v169, 0x800, v197
    v_and_or_b32 v169, v169, s80, v6
    v_add_u32 v170, 0x800, v201
    v_and_or_b32 v170, v170, s80, v6
    v_add_u32 v171, 0x800, v205
    v_and_or_b32 v171, v171, s80, v6
    buffer_store_dwordx4 v[168:171], v4, s[28:31], s54 offen offset:512 sc1
    v_add_u32 v172, 0x800, v209
    v_and_or_b32 v172, v172, s80, v6
    v_add_u32 v173, 0x800, v213
    v_and_or_b32 v173, v173, s80, v6
    v_add_u32 v174, 0x800, v217
    v_and_or_b32 v174, v174, s80, v6
    v_add_u32 v175, 0x800, v221
    v_and_or_b32 v175, v175, s80, v6
    buffer_store_dwordx4 v[172:175], v4, s[28:31], s54 offen offset:768 sc1
    s_mov_b32 exec_hi, 0xffff
    v_add_u32 v176, 0x800, v194
    v_and_or_b32 v176, v176, s80, v6
    v_add_u32 v177, 0x800, v198
    v_and_or_b32 v177, v177, s80, v6
    v_add_u32 v178, 0x800, v202
    v_and_or_b32 v178, v178, s80, v6
    v_add_u32 v179, 0x800, v206
    v_and_or_b32 v179, v179, s80, v6
    buffer_store_dwordx4 v[176:179], v4, s[28:31], s54 offen offset:1024 sc1
    v_add_u32 v180, 0x800, v210
    v_and_or_b32 v180, v180, s80, v6
    v_add_u32 v181, 0x800, v214
    v_and_or_b32 v181, v181, s80, v6
    v_add_u32 v182, 0x800, v218
    v_and_or_b32 v182, v182, s80, v6
    v_add_u32 v183, 0x800, v222
    v_and_or_b32 v183, v183, s80, v6
    buffer_store_dwordx4 v[180:183], v4, s[28:31], s54 offen offset:1280 sc1
    v_add_u32 v184, 0x800, v195
    v_and_or_b32 v184, v184, s80, v6
    v_add_u32 v185, 0x800, v199
    v_and_or_b32 v185, v185, s80, v6
    v_add_u32 v186, 0x800, v203
    v_and_or_b32 v186, v186, s80, v6
    v_add_u32 v187, 0x800, v207
    v_and_or_b32 v187, v187, s80, v6
    buffer_store_dwordx4 v[184:187], v4, s[28:31], s54 offen offset:1536 sc1
    v_add_u32 v188, 0x800, v211
    v_and_or_b32 v188, v188, s80, v6
    v_add_u32 v189, 0x800, v215
    v_and_or_b32 v189, v189, s80, v6
    v_add_u32 v190, 0x800, v219
    v_and_or_b32 v190, v190, s80, v6
    v_add_u32 v191, 0x800, v223
    v_and_or_b32 v191, v191, s80, v6
    buffer_store_dwordx4 v[188:191], v4, s[28:31], s54 offen offset:1792 sc1
EXIT:
    s_endpgm
.section .rodata,"a"
.p2align 6
.amdhsa_kernel standalone__gqa_block_cached__sampling_kernel
  .amdhsa_next_free_vgpr 256
  .amdhsa_next_free_sgpr 102
  .amdhsa_accum_offset 256
  .amdhsa_group_segment_fixed_size 0
  .amdhsa_kernarg_size 64
  .amdhsa_user_sgpr_count 2
  .amdhsa_user_sgpr_kernarg_segment_ptr 1
  .amdhsa_system_sgpr_workgroup_id_x 1
.end_amdhsa_kernel
```
